```python
import torch

def _softmax(x, axis=-1):
    return torch.softmax(x, dim=axis)
def _gelu(x):
    return torch.nn.functional.gelu(x, approximate="tanh")
def _silu(x):
    return torch.nn.functional.silu(x)
def _sigmoid(x):
    return torch.sigmoid(x)
def _layernorm(x, axis=-1, eps=1e-5):
    m = x.mean(dim=axis, keepdim=True)
    v = x.var(dim=axis, keepdim=True, unbiased=False)
    return (x - m) / torch.sqrt(v + eps)
def _scatter_add(tgt, idx, src, axis=0):
    return tgt.clone().index_add_(axis, idx, src)
def _segment_sum(src, seg, n):
    out = torch.zeros((n,) + src.shape[1:], dtype=src.dtype)
    return out.index_add_(0, seg, src)
def _pad(x, pw):
    flat = tuple(v for pair in reversed(pw) for v in pair)
    return torch.nn.functional.pad(x, flat)

kernel_name = 'concat_heads__compressed_kv_cla__mha_block_cached__decode'

def setup_inputs():

    _w = (lambda a: (lambda t: t.to(torch.bfloat16) if t.is_floating_point() else t)(torch.as_tensor(a)))
    def _A_setup():
        B, H, Sq, Sk, D, M = 1, 32, 1, 8192, 128, 512
        Dc = 4 * D
        return {
            "x": _w((lambda *s: torch.randn(*s, dtype=torch.bfloat16) * 3.2)(B, Sq, M)),
            "c_kv": _w((lambda *s: torch.randn(*s, dtype=torch.bfloat16) * 0.1)(B, Sk, Dc)),
            "w_q": _w((lambda *s: torch.randn(*s, dtype=torch.bfloat16) * 6.4)(M, H, D) * (M ** -0.5)),
            "w_uk": _w((lambda *s: torch.randn(*s, dtype=torch.bfloat16) * 6.4)(Dc, H, D) * (Dc ** -0.5)),
            "w_uv": _w((lambda *s: torch.randn(*s, dtype=torch.bfloat16) * 0.1)(Dc, H, D) * (Dc ** -0.5)),
            "w_o": _w((lambda *s: torch.randn(*s, dtype=torch.bfloat16) * 0.1)(H, D, M) * ((H * D) ** -0.5)),
        }
    _A_in = _A_setup()

    def _B_setup():
        B, Sq, D = 1, 1, 512
        H, Sk, Dh = 32, 8192, 128
        return {
            "x": _w((lambda *s: torch.randn(*s, dtype=torch.bfloat16) * 1.6)(B, Sq, D)),
            "k_cache": _w((lambda *s: torch.randn(*s, dtype=torch.bfloat16) * 1.6)(B, H, Sk, Dh)),
            "v_cache": _w((lambda *s: torch.randn(*s, dtype=torch.bfloat16) * 0.05)(B, H, Sk, Dh)),
            "wq": _w((lambda *s: torch.randn(*s, dtype=torch.bfloat16) * 1.6)(D, H * Dh) * (D ** -0.5)),
            "wo": _w((lambda *s: torch.randn(*s, dtype=torch.bfloat16) * 0.05)(H * Dh, D) * ((H * Dh) ** -0.5)),
        }
    _B_in = _B_setup()

    return {
        "A_x": _A_in["x"],
        "A_c_kv": _A_in["c_kv"],
        "A_w_q": _A_in["w_q"],
        "A_w_uk": _A_in["w_uk"],
        "A_w_uv": _A_in["w_uv"],
        "A_w_o": _A_in["w_o"],
        "B_x": _B_in["x"],
        "B_k_cache": _B_in["k_cache"],
        "B_v_cache": _B_in["v_cache"],
        "B_wq": _B_in["wq"],
        "B_wo": _B_in["wo"],
    }

def reference(A_x, A_c_kv, A_w_q, A_w_uk, A_w_uv, A_w_o, B_x, B_k_cache, B_v_cache, B_wq, B_wo):
    def _A_ref(x, c_kv, w_q, w_uk, w_uv, w_o):
        B, Sq, M = x.shape[0], x.shape[1], x.shape[2]
        Sk = c_kv.shape[1]
        H, D = w_q.shape[1], w_q.shape[2]
        q = torch.einsum("bqm,mhd->bhqd", x, w_q)
        k = torch.einsum("bkc,chd->bhkd", c_kv, w_uk)
        v = torch.einsum("bkc,chd->bhkd", c_kv, w_uv)
        scores = torch.einsum("bhqd,bhkd->bhqk", q, k) * (D ** -0.5)
        off = Sk - Sq
        qi = torch.arange(Sq)[:, None]
        kj = torch.arange(Sk)[None, :]
        cmask = kj <= (qi + off)
        scores = torch.where(cmask[None, None], scores, -1e9)
        p = _softmax(scores, axis=-1)
        ctx = torch.einsum("bhqk,bhkd->bhqd", p, v)
        return torch.einsum("bhqd,hdm->bqm", ctx, w_o)

    def _B_ref(x, k_cache, v_cache, wq, wo):
        B, Sq, D = x.shape
        H, Dh = 32, 128
        q = (lambda x, *d: x.permute(*d))((x @ wq).reshape(B, Sq, H, Dh), 0, 2, 1, 3)
        scores = torch.einsum("bhqd,bhkd->bhqk", q, k_cache) * (Dh ** -0.5)
        p = _softmax(scores, axis=-1)
        o = torch.einsum("bhqk,bhkd->bhqd", p, v_cache)
        return (lambda x, *d: x.permute(*d))(o, 0, 2, 1, 3).reshape(B, Sq, H * Dh) @ wo

    a = _A_ref(A_x, A_c_kv, A_w_q, A_w_uk, A_w_uv, A_w_o)
    b = _B_ref(B_x, B_k_cache, B_v_cache, B_wq, B_wo)
    return torch.concatenate([a, b], axis=-1)
```

```asm
; @launch grid=(256,1,1) block=(384,1,1) lds=160768
.amdgcn_target "amdgcn-amd-amdhsa--gfx950"
.text
.globl concat_heads__compressed_kv_cla__mha_block_cached__decode_kernel
.p2align 8
.type concat_heads__compressed_kv_cla__mha_block_cached__decode_kernel,@function
concat_heads__compressed_kv_cla__mha_block_cached__decode_kernel:
    s_load_dwordx16 s[16:31], s[0:1], 0
    s_load_dwordx8 s[32:39], s[0:1], 64
    s_load_dwordx4 s[40:43], s[0:1], 96
    s_cmpk_ge_u32 s2, 256
    s_cbranch_scc1 L_END
    v_lshrrev_b32 v1, 6, v0
    v_and_b32 v0, 63, v0
    v_readfirstlane_b32 s3, v1
    v_lshrrev_b32 v2, 4, v0
    v_and_b32 v3, 15, v0
    s_and_b32 s71, s2, 7
    s_lshr_b32 s70, s2, 3
    s_add_u32 s70, s70, s71
    s_and_b32 s70, s70, 31
    s_cmp_ge_u32 s3, 2
    s_cbranch_scc1 L_BW
    s_and_b32 s7, s70, 1
    s_lshl1_add_u32 s7, s3, s7
    s_xor_b32 s72, s71, s7
    s_bfe_u32 s4, s2, 0x20003
    s_lshl2_add_u32 s4, s71, s4
    s_lshr_b32 s5, s2, 5
    s_lshl_b32 s6, s5, 19
    s_lshl_b32 s7, s4, 8
    s_add_u32 s56, s6, s7
    v_lshlrev_b32 v8, 17, v2
    v_lshl_add_u32 v8, v3, 4, v8
    s_lshl_b32 s55, s5, 7
    v_lshl_add_u32 v9, v0, 1, s55
    s_lshl_b32 s10, 1, 22
    s_mov_b32 s11, 0x20000
    s_mov_b32 s54, s56
    s_cmp_eq_u32 s72, 0
    s_cbranch_scc1 L_RESET
L_P1_b0:
    s_waitcnt lgkmcnt(0)
L_P1_b2:
    s_lshl_b32 s7, s4, 8
    s_cmp_eq_u32 s3, 0
    s_cselect_b64 s[8:9], s[34:35], s[20:21]
    s_cselect_b64 s[12:13], s[28:29], s[16:17]
    global_load_ushort v9, v9, s[12:13]
    buffer_load_dwordx4 v[16:19], v8, s[8:11], s56 offen nt
    s_addk_i32 s56, 0x2000
    buffer_load_dwordx4 v[20:23], v8, s[8:11], s56 offen nt
    s_addk_i32 s56, 0x2000
    buffer_load_dwordx4 v[24:27], v8, s[8:11], s56 offen nt
    s_addk_i32 s56, 0x2000
    buffer_load_dwordx4 v[28:31], v8, s[8:11], s56 offen nt
    s_addk_i32 s56, 0x2000
    buffer_load_dwordx4 v[32:35], v8, s[8:11], s56 offen nt
    s_addk_i32 s56, 0x2000
    buffer_load_dwordx4 v[36:39], v8, s[8:11], s56 offen nt
    s_addk_i32 s56, 0x2000
    buffer_load_dwordx4 v[40:43], v8, s[8:11], s56 offen nt
    s_addk_i32 s56, 0x2000
    buffer_load_dwordx4 v[44:47], v8, s[8:11], s56 offen nt
    s_addk_i32 s56, 0x2000
    buffer_load_dwordx4 v[48:51], v8, s[8:11], s56 offen nt
    s_addk_i32 s56, 0x2000
    buffer_load_dwordx4 v[52:55], v8, s[8:11], s56 offen nt
    s_addk_i32 s56, 0x2000
    buffer_load_dwordx4 v[56:59], v8, s[8:11], s56 offen nt
    s_addk_i32 s56, 0x2000
    buffer_load_dwordx4 v[60:63], v8, s[8:11], s56 offen nt
    s_addk_i32 s56, 0x2000
    buffer_load_dwordx4 v[64:67], v8, s[8:11], s56 offen nt
    s_addk_i32 s56, 0x2000
    buffer_load_dwordx4 v[68:71], v8, s[8:11], s56 offen nt
    s_addk_i32 s56, 0x2000
    buffer_load_dwordx4 v[72:75], v8, s[8:11], s56 offen nt
    s_addk_i32 s56, 0x2000
    buffer_load_dwordx4 v[76:79], v8, s[8:11], s56 offen nt
    s_lshr_b32 s6, s5, 1
    s_lshl_b32 s6, s6, 20
    s_add_u32 s6, s6, s7
    s_and_b32 s7, s5, 1
    s_lshl_b32 s7, s7, 16
    s_add_u32 s6, s6, s7
    s_cmp_eq_u32 s3, 0
    s_cselect_b32 s60, 0x10000, 0
    s_cselect_b64 s[12:13], s[24:25], s[22:23]
    s_cselect_b32 s56, s6, s54
    s_cselect_b64 vcc, -1, 0
    s_mov_b32 s14, s10
    s_mov_b32 s15, 0x20000
    v_lshrrev_b32 v10, 2, v3
    v_lshlrev_b32 v10, 17, v10
    v_lshl_add_u32 v10, v2, 6, v10
    v_and_b32 v11, 3, v0
    v_lshl_add_u32 v10, v11, 4, v10
    v_lshl_add_u32 v11, v2, 17, v8
    v_cndmask_b32 v10, v10, v11, vcc
    v_and_b32 v11, 1, v3
    v_lshlrev_b32 v11, 4, v11
    v_mov_b32 v12, 0xffff
    v_lshlrev_b32 v11, v11, v12
    v_bfe_u32 v12, v3, 1, 2
    v_cmp_eq_u32 vcc, 0, v12
    s_nop 1
    v_cndmask_b32 v4, 0, v11, vcc
    v_cmp_eq_u32 vcc, 1, v12
    s_nop 1
    v_cndmask_b32 v5, 0, v11, vcc
    v_cmp_eq_u32 vcc, 2, v12
    s_nop 1
    v_cndmask_b32 v6, 0, v11, vcc
    v_cmp_eq_u32 vcc, 3, v12
    s_nop 1
    v_cndmask_b32 v7, 0, v11, vcc
    s_waitcnt vmcnt(16)
    v_lshl_or_b32 v9, v9, 16, v9
    s_nop 1
    v_and_b32_dpp v84, v9, v4 row_newbcast:0 row_mask:0xf bank_mask:0xf
    v_and_b32_dpp v85, v9, v5 row_newbcast:0 row_mask:0xf bank_mask:0xf
    v_and_b32_dpp v86, v9, v6 row_newbcast:0 row_mask:0xf bank_mask:0xf
    v_and_b32_dpp v87, v9, v7 row_newbcast:0 row_mask:0xf bank_mask:0xf
    s_waitcnt vmcnt(15)
    s_nop 0
    v_mfma_f32_16x16x32_bf16 v[80:83], v[16:19], v[84:87], 0
    buffer_load_dwordx4 v[96:99], v10, s[12:15], s56 offen nt
    s_addk_i32 s56, 0x2000
    v_and_b32_dpp v88, v9, v4 row_newbcast:1 row_mask:0xf bank_mask:0xf
    v_and_b32_dpp v89, v9, v5 row_newbcast:1 row_mask:0xf bank_mask:0xf
    v_and_b32_dpp v90, v9, v6 row_newbcast:1 row_mask:0xf bank_mask:0xf
    v_and_b32_dpp v91, v9, v7 row_newbcast:1 row_mask:0xf bank_mask:0xf
    s_waitcnt vmcnt(15)
    s_nop 0
    v_mfma_f32_16x16x32_bf16 v[80:83], v[20:23], v[88:91], v[80:83]
    buffer_load_dwordx4 v[100:103], v10, s[12:15], s56 offen nt
    s_addk_i32 s56, 0x2000
    v_and_b32_dpp v84, v9, v4 row_newbcast:2 row_mask:0xf bank_mask:0xf
    v_and_b32_dpp v85, v9, v5 row_newbcast:2 row_mask:0xf bank_mask:0xf
    v_and_b32_dpp v86, v9, v6 row_newbcast:2 row_mask:0xf bank_mask:0xf
    v_and_b32_dpp v87, v9, v7 row_newbcast:2 row_mask:0xf bank_mask:0xf
    s_waitcnt vmcnt(15)
    s_nop 0
    v_mfma_f32_16x16x32_bf16 v[80:83], v[24:27], v[84:87], v[80:83]
    buffer_load_dwordx4 v[104:107], v10, s[12:15], s56 offen nt
    s_addk_i32 s56, 0x2000
    s_mov_b32 s52, 0
    v_mov_b32 v1, 0x24000
    v_lshlrev_b32 v13, 4, v0
    s_mul_i32 s57, s3, 0x1400
    s_mul_i32 s6, s4, 0x5300
    s_add_u32 s44, s42, s6
    s_addc_u32 s45, s43, 0
    s_mov_b32 s46, 0x5200
    s_mov_b32 s47, 0x20000
    s_mov_b32 s48, s42
    s_mov_b32 s49, s43
    s_mov_b32 s50, 0x400000
    s_mov_b32 s51, 0x20000
    s_lshl_b32 s6, s4, 8
    s_add_u32 s6, s6, 0x380000
    s_add_u32 s68, s42, s6
    s_addc_u32 s69, s43, 0
    s_lshl_b32 s6, s5, 8
    s_add_u32 s6, s6, s57
    v_lshl_add_u32 v12, v2, 3, v3
    v_lshlrev_b32 v12, 3, v12
    v_add_u32 v12, s6, v12
    v_mov_b32 v11, 0x40000000
    v_cmp_gt_u32 vcc, 8, v3
    s_lshl_b32 s7, s4, 3
    s_lshl_b32 s66, s70, 3
    v_cndmask_b32 v12, v11, v12, vcc
    s_cmp_eq_u32 s3, 0
    s_cselect_b32 s67, s70, s4
    s_mul_i32 s6, s67, 0x5300
    s_add_u32 s57, s57, s6
    v_and_b32_dpp v88, v9, v4 row_newbcast:3 row_mask:0xf bank_mask:0xf
    v_and_b32_dpp v89, v9, v5 row_newbcast:3 row_mask:0xf bank_mask:0xf
    v_and_b32_dpp v90, v9, v6 row_newbcast:3 row_mask:0xf bank_mask:0xf
    v_and_b32_dpp v91, v9, v7 row_newbcast:3 row_mask:0xf bank_mask:0xf
    s_waitcnt vmcnt(15)
    s_nop 0
    v_mfma_f32_16x16x32_bf16 v[80:83], v[28:31], v[88:91], v[80:83]
    buffer_load_dwordx4 v[108:111], v10, s[12:15], s56 offen nt
    s_addk_i32 s56, 0x2000
    v_and_b32_dpp v84, v9, v4 row_newbcast:4 row_mask:0xf bank_mask:0xf
    v_and_b32_dpp v85, v9, v5 row_newbcast:4 row_mask:0xf bank_mask:0xf
    v_and_b32_dpp v86, v9, v6 row_newbcast:4 row_mask:0xf bank_mask:0xf
    v_and_b32_dpp v87, v9, v7 row_newbcast:4 row_mask:0xf bank_mask:0xf
    s_waitcnt vmcnt(15)
    s_nop 0
    v_mfma_f32_16x16x32_bf16 v[80:83], v[32:35], v[84:87], v[80:83]
    buffer_load_dwordx4 v[112:115], v10, s[12:15], s56 offen nt
    s_addk_i32 s56, 0x2000
    v_and_b32_dpp v88, v9, v4 row_newbcast:5 row_mask:0xf bank_mask:0xf
    v_and_b32_dpp v89, v9, v5 row_newbcast:5 row_mask:0xf bank_mask:0xf
    v_and_b32_dpp v90, v9, v6 row_newbcast:5 row_mask:0xf bank_mask:0xf
    v_and_b32_dpp v91, v9, v7 row_newbcast:5 row_mask:0xf bank_mask:0xf
    s_waitcnt vmcnt(15)
    s_nop 0
    v_mfma_f32_16x16x32_bf16 v[80:83], v[36:39], v[88:91], v[80:83]
    buffer_load_dwordx4 v[116:119], v10, s[12:15], s56 offen nt
    s_addk_i32 s56, 0x2000
    v_and_b32_dpp v84, v9, v4 row_newbcast:6 row_mask:0xf bank_mask:0xf
    v_and_b32_dpp v85, v9, v5 row_newbcast:6 row_mask:0xf bank_mask:0xf
    v_and_b32_dpp v86, v9, v6 row_newbcast:6 row_mask:0xf bank_mask:0xf
    v_and_b32_dpp v87, v9, v7 row_newbcast:6 row_mask:0xf bank_mask:0xf
    s_waitcnt vmcnt(15)
    s_nop 0
    v_mfma_f32_16x16x32_bf16 v[80:83], v[40:43], v[84:87], v[80:83]
    buffer_load_dwordx4 v[120:123], v10, s[12:15], s56 offen nt
    s_addk_i32 s56, 0x2000
    v_and_b32_dpp v88, v9, v4 row_newbcast:7 row_mask:0xf bank_mask:0xf
    v_and_b32_dpp v89, v9, v5 row_newbcast:7 row_mask:0xf bank_mask:0xf
    v_and_b32_dpp v90, v9, v6 row_newbcast:7 row_mask:0xf bank_mask:0xf
    v_and_b32_dpp v91, v9, v7 row_newbcast:7 row_mask:0xf bank_mask:0xf
    s_waitcnt vmcnt(15)
    s_nop 0
    v_mfma_f32_16x16x32_bf16 v[80:83], v[44:47], v[88:91], v[80:83]
    buffer_load_dwordx4 v[124:127], v10, s[12:15], s56 offen nt
    s_addk_i32 s56, 0x2000
    s_add_u32 s56, s56, s60
    v_and_b32_dpp v84, v9, v4 row_newbcast:8 row_mask:0xf bank_mask:0xf
    v_and_b32_dpp v85, v9, v5 row_newbcast:8 row_mask:0xf bank_mask:0xf
    v_and_b32_dpp v86, v9, v6 row_newbcast:8 row_mask:0xf bank_mask:0xf
    v_and_b32_dpp v87, v9, v7 row_newbcast:8 row_mask:0xf bank_mask:0xf
    s_waitcnt vmcnt(15)
    s_nop 0
    v_mfma_f32_16x16x32_bf16 v[80:83], v[48:51], v[84:87], v[80:83]
    buffer_load_dwordx4 v[128:131], v10, s[12:15], s56 offen nt
    s_addk_i32 s56, 0x2000
    v_and_b32_dpp v88, v9, v4 row_newbcast:9 row_mask:0xf bank_mask:0xf
    v_and_b32_dpp v89, v9, v5 row_newbcast:9 row_mask:0xf bank_mask:0xf
    v_and_b32_dpp v90, v9, v6 row_newbcast:9 row_mask:0xf bank_mask:0xf
    v_and_b32_dpp v91, v9, v7 row_newbcast:9 row_mask:0xf bank_mask:0xf
    s_waitcnt vmcnt(15)
    s_nop 0
    v_mfma_f32_16x16x32_bf16 v[80:83], v[52:55], v[88:91], v[80:83]
    buffer_load_dwordx4 v[132:135], v10, s[12:15], s56 offen nt
    s_addk_i32 s56, 0x2000
    v_and_b32_dpp v84, v9, v4 row_newbcast:10 row_mask:0xf bank_mask:0xf
    v_and_b32_dpp v85, v9, v5 row_newbcast:10 row_mask:0xf bank_mask:0xf
    v_and_b32_dpp v86, v9, v6 row_newbcast:10 row_mask:0xf bank_mask:0xf
    v_and_b32_dpp v87, v9, v7 row_newbcast:10 row_mask:0xf bank_mask:0xf
    s_waitcnt vmcnt(15)
    s_nop 0
    v_mfma_f32_16x16x32_bf16 v[80:83], v[56:59], v[84:87], v[80:83]
    buffer_load_dwordx4 v[136:139], v10, s[12:15], s56 offen nt
    s_addk_i32 s56, 0x2000
    v_and_b32_dpp v88, v9, v4 row_newbcast:11 row_mask:0xf bank_mask:0xf
    v_and_b32_dpp v89, v9, v5 row_newbcast:11 row_mask:0xf bank_mask:0xf
    v_and_b32_dpp v90, v9, v6 row_newbcast:11 row_mask:0xf bank_mask:0xf
    v_and_b32_dpp v91, v9, v7 row_newbcast:11 row_mask:0xf bank_mask:0xf
    s_waitcnt vmcnt(15)
    s_nop 0
    v_mfma_f32_16x16x32_bf16 v[80:83], v[60:63], v[88:91], v[80:83]
    buffer_load_dwordx4 v[140:143], v10, s[12:15], s56 offen nt
    s_addk_i32 s56, 0x2000
    s_barrier
    v_and_b32_dpp v84, v9, v4 row_newbcast:12 row_mask:0xf bank_mask:0xf
    v_and_b32_dpp v85, v9, v5 row_newbcast:12 row_mask:0xf bank_mask:0xf
    v_and_b32_dpp v86, v9, v6 row_newbcast:12 row_mask:0xf bank_mask:0xf
    v_and_b32_dpp v87, v9, v7 row_newbcast:12 row_mask:0xf bank_mask:0xf
    s_waitcnt vmcnt(15)
    s_nop 0
    v_mfma_f32_16x16x32_bf16 v[80:83], v[64:67], v[84:87], v[80:83]
    buffer_load_dwordx4 v[144:147], v10, s[12:15], s56 offen nt
    s_addk_i32 s56, 0x2000
    v_and_b32_dpp v88, v9, v4 row_newbcast:13 row_mask:0xf bank_mask:0xf
    v_and_b32_dpp v89, v9, v5 row_newbcast:13 row_mask:0xf bank_mask:0xf
    v_and_b32_dpp v90, v9, v6 row_newbcast:13 row_mask:0xf bank_mask:0xf
    v_and_b32_dpp v91, v9, v7 row_newbcast:13 row_mask:0xf bank_mask:0xf
    s_waitcnt vmcnt(15)
    s_nop 0
    v_mfma_f32_16x16x32_bf16 v[80:83], v[68:71], v[88:91], v[80:83]
    buffer_load_dwordx4 v[148:151], v10, s[12:15], s56 offen nt
    s_addk_i32 s56, 0x2000
    v_and_b32_dpp v84, v9, v4 row_newbcast:14 row_mask:0xf bank_mask:0xf
    v_and_b32_dpp v85, v9, v5 row_newbcast:14 row_mask:0xf bank_mask:0xf
    v_and_b32_dpp v86, v9, v6 row_newbcast:14 row_mask:0xf bank_mask:0xf
    v_and_b32_dpp v87, v9, v7 row_newbcast:14 row_mask:0xf bank_mask:0xf
    s_waitcnt vmcnt(15)
    s_nop 0
    v_mfma_f32_16x16x32_bf16 v[80:83], v[72:75], v[84:87], v[80:83]
    buffer_load_dwordx4 v[152:155], v10, s[12:15], s56 offen nt
    s_addk_i32 s56, 0x2000
    v_and_b32_dpp v88, v9, v4 row_newbcast:15 row_mask:0xf bank_mask:0xf
    v_and_b32_dpp v89, v9, v5 row_newbcast:15 row_mask:0xf bank_mask:0xf
    v_and_b32_dpp v90, v9, v6 row_newbcast:15 row_mask:0xf bank_mask:0xf
    v_and_b32_dpp v91, v9, v7 row_newbcast:15 row_mask:0xf bank_mask:0xf
    s_waitcnt vmcnt(15)
    s_nop 0
    v_mfma_f32_16x16x32_bf16 v[80:83], v[76:79], v[88:91], v[80:83]
    buffer_load_dwordx4 v[156:159], v10, s[12:15], s56 offen nt
    s_addk_i32 s56, 0x2000
    s_load_dwordx2 s[58:59], s[40:41], s7
    s_load_dwordx2 s[64:65], s[40:41], s66
    v_lshlrev_b32 v14, 2, v0
    s_waitcnt lgkmcnt(0)
    s_and_b64 s[58:59], s[58:59], s[64:65]
    s_and_b32 s6, s58, s59
    s_cbranch_scc1 L_P1_rd
    s_lshr_b32 s7, s7, 2
    s_lshr_b32 s66, s66, 2
    s_lshl_b64 s[58:59], 3, s7
    s_lshl_b64 s[64:65], 3, s66
    s_or_b64 s[58:59], s[58:59], s[64:65]
L_P1_rp:
    global_load_dword v15, v14, s[40:41] sc1
    s_waitcnt vmcnt(0)
    v_cmp_eq_u32 vcc, 0, v15
    s_nop 0
    s_and_b64 vcc, vcc, s[58:59]
    s_cbranch_scc0 L_P1_rd
    s_add_u32 s52, s52, 1
    s_cmp_lt_u32 s52, 400000
    s_cbranch_scc1 L_P1_rp
L_P1_rd:
    v_cvt_pk_bf16_f32 v80, v80, v81
    v_cvt_pk_bf16_f32 v81, v82, v83
    v_min_u32 v80, -2, v80
    v_min_u32 v81, -2, v81
    buffer_store_dwordx2 v[80:81], v12, s[44:47], 0 offen sc1
    s_cmp_eq_u32 s3, 0
    s_cbranch_scc1 L_P1_nosr
    v_mov_b32 v16, -1
    v_mov_b32 v17, -1
    v_mov_b32 v18, -1
    v_mov_b32 v19, -1
    s_mul_i32 s6, s5, 0x300
    s_add_u32 s6, s6, 0x2800
    s_mul_i32 s7, s4, 0x5300
    s_add_u32 s6, s6, s7
    s_mov_b64 exec, 0xffffff
    buffer_store_dwordx4 v[16:19], v13, s[48:51], s6 offen sc1
    s_mul_i32 s6, s71, 0x300
    s_mul_i32 s7, s70, 0x5300
    s_add_u32 s6, s6, s7
    s_add_u32 s6, s6, 0x2980
    buffer_store_dwordx4 v[16:19], v13, s[48:51], s6 offen sc1
    s_mov_b64 exec, -1
    s_cmp_eq_u32 s70, 0
    s_cbranch_scc0 L_P1_nosr
    v_mov_b32 v20, 0
    v_mov_b32 v21, 0
    v_mov_b32 v22, 0
    v_mov_b32 v23, 0
    v_lshrrev_b32 v24, 5, v0
    v_lshlrev_b32 v24, 14, v24
    v_bfe_u32 v25, v0, 2, 3
    v_lshl_add_u32 v24, v25, 8, v24
    v_and_b32 v25, 3, v0
    v_lshl_add_u32 v24, v25, 4, v24
    s_lshl_b32 s6, s71, 11
    s_add_u32 s6, s6, 0x3a0000
    buffer_store_dwordx4 v[20:23], v24, s[48:51], s6 offen sc1
L_P1_nosr:
    s_waitcnt vmcnt(0)
    global_load_dword v15, v14, s[40:41] sc1
    v_lshlrev_b32 v10, 3, v0
L_pl_1:
    buffer_load_dwordx2 v[32:33], v10, s[48:51], s57 offen offset:0 sc1
    buffer_load_dwordx2 v[34:35], v10, s[48:51], s57 offen offset:512 sc1
    buffer_load_dwordx2 v[36:37], v10, s[48:51], s57 offen offset:1024 sc1
    buffer_load_dwordx2 v[38:39], v10, s[48:51], s57 offen offset:1536 sc1
    s_waitcnt vmcnt(0)
L_plc_2:
    v_max_u32 v11, v32, v33
    v_max3_u32 v11, v34, v35, v11
    v_max3_u32 v11, v36, v37, v11
    v_max3_u32 v11, v38, v39, v11
    v_cmp_eq_u32 vcc, -1, v11
    s_nop 0
    s_and_b64 vcc, vcc, exec
    s_cbranch_scc0 L_pld_3
    s_mov_b64 exec, vcc
    s_sleep 32
    s_add_u32 s52, s52, 1
    s_cmp_lt_u32 s52, 400000
    s_cbranch_scc1 L_pl_1
L_pld_3:
    s_mov_b64 exec, -1
    v_lshlrev_b32 v160, 16, v32
    v_and_b32 v161, 0xffff0000, v32
    v_lshlrev_b32 v162, 16, v33
    v_and_b32 v163, 0xffff0000, v33
    v_lshlrev_b32 v164, 16, v34
    v_and_b32 v165, 0xffff0000, v34
    v_lshlrev_b32 v166, 16, v35
    v_and_b32 v167, 0xffff0000, v35
    v_lshlrev_b32 v168, 16, v36
    v_and_b32 v169, 0xffff0000, v36
    v_lshlrev_b32 v170, 16, v37
    v_and_b32 v171, 0xffff0000, v37
    v_lshlrev_b32 v172, 16, v38
    v_and_b32 v173, 0xffff0000, v38
    v_lshlrev_b32 v174, 16, v39
    v_and_b32 v175, 0xffff0000, v39
    v_add_f32 v160, v160, v164
    v_add_f32 v168, v168, v172
    v_add_f32 v161, v161, v165
    v_add_f32 v169, v169, v173
    v_add_f32 v162, v162, v166
    v_add_f32 v170, v170, v174
    v_add_f32 v163, v163, v167
    v_add_f32 v171, v171, v175
    v_add_f32 v160, v160, v168
    v_mov_b32 v164, v160
    v_add_f32 v161, v161, v169
    v_mov_b32 v165, v161
    v_add_f32 v162, v162, v170
    v_mov_b32 v166, v162
    v_add_f32 v163, v163, v171
    v_mov_b32 v167, v163
    v_permlane32_swap_b32 v160, v164
    v_permlane32_swap_b32 v161, v165
    v_permlane32_swap_b32 v162, v166
    v_permlane32_swap_b32 v163, v167
    v_add_f32 v160, v160, v164
    v_add_f32 v161, v161, v165
    v_add_f32 v162, v162, v166
    v_add_f32 v163, v163, v167
    v_cvt_pk_bf16_f32 v160, v160, v161
    v_cvt_pk_bf16_f32 v162, v162, v163
    v_bfe_u32 v11, v0, 3, 2
    v_lshl_add_u32 v11, v11, 6, v1
    v_and_b32 v14, 7, v0
    v_lshl_add_u32 v11, v14, 1, v11
    s_lshl_b32 s6, s3, 8
    v_add_u32 v11, s6, v11
    ds_write_b16 v11, v160 offset:256
    ds_write_b16_d16_hi v11, v160 offset:272
    ds_write_b16 v11, v162 offset:288
    ds_write_b16_d16_hi v11, v162 offset:304
    s_waitcnt lgkmcnt(0)
    s_cmp_eq_u32 s3, 0
    s_cbranch_scc0 L_W1
    v_mov_b32 v11, 1
    s_mov_b64 exec, 1
    ds_add_u32 v1, v11 offset:0
    s_mov_b64 exec, -1
    v_and_b32 v11, 7, v0
    v_lshrrev_b32 v12, 3, v0
    v_lshl_add_u32 v12, v11, 3, v12
    v_lshlrev_b32 v12, 8, v12
    s_lshl_b32 s6, s4, 3
    s_add_u32 s6, s6, 0x390000
    v_add_u32 v12, s6, v12
    s_lshl_b32 s6, s4, 10
    s_lshl_b32 s7, s5, 7
    v_lshrrev_b32 v13, 3, v0
    v_lshlrev_b32 v13, 15, v13
    v_lshl_add_u32 v13, v11, 4, v13
    s_add_u32 s6, s6, s7
    s_add_u32 s54, s6, 0x100000
    s_load_dword s6, s[68:69], 0x4000 glc
    s_waitcnt lgkmcnt(0)
    s_cmp_ge_i32 s6, 0
    s_cbranch_scc1 L_spd_5
    s_sleep 96
    s_load_dword s6, s[68:69], 0x4000 glc
    s_waitcnt lgkmcnt(0)
    s_cmp_ge_i32 s6, 0
    s_cbranch_scc1 L_spd_5
    s_sleep 96
    s_load_dword s6, s[68:69], 0x4000 glc
    s_waitcnt lgkmcnt(0)
    s_cmp_ge_i32 s6, 0
    s_cbranch_scc1 L_spd_5
    s_sleep 96
L_sp_4:
    s_load_dword s6, s[68:69], 0x4000 glc
    s_waitcnt lgkmcnt(0)
    s_cmp_ge_i32 s6, 0
    s_cbranch_scc1 L_spd_5
    s_sleep 8
    s_add_u32 s52, s52, 1
    s_cmp_lt_u32 s52, 400000
    s_cbranch_scc1 L_sp_4
L_spd_5:
    buffer_load_dwordx2 v[8:9], v12, s[48:51], 0 offen sc1
    buffer_load_dwordx4 v[160:163], v13, s[48:51], s54 offen sc1
    s_add_u32 s54, s54, 0x40000
    buffer_load_dwordx4 v[164:167], v13, s[48:51], s54 offen sc1
    s_add_u32 s54, s54, 0x40000
    buffer_load_dwordx4 v[168:171], v13, s[48:51], s54 offen sc1
    s_add_u32 s54, s54, 0x40000
    buffer_load_dwordx4 v[172:175], v13, s[48:51], s54 offen sc1
    s_add_u32 s54, s54, 0x40000
    buffer_load_dwordx4 v[176:179], v13, s[48:51], s54 offen sc1
    s_add_u32 s54, s54, 0x40000
    buffer_load_dwordx4 v[180:183], v13, s[48:51], s54 offen sc1
    s_add_u32 s54, s54, 0x40000
    buffer_load_dwordx4 v[184:187], v13, s[48:51], s54 offen sc1
    s_add_u32 s54, s54, 0x40000
    buffer_load_dwordx4 v[188:191], v13, s[48:51], s54 offen sc1
    s_add_u32 s54, s54, 0x40000
    v_mov_b32 v11, 1
    s_mov_b64 exec, 1
    ds_add_u32 v1, v11 offset:24
    s_mov_b64 exec, -1
    s_waitcnt vmcnt(8)
    v_mov_b32 v10, v8
    s_nop 1
    v_max_f32_dpp v10, v10, v10 row_ror:1 row_mask:0xf bank_mask:0xf
    s_nop 1
    v_max_f32_dpp v10, v10, v10 row_ror:2 row_mask:0xf bank_mask:0xf
    s_nop 1
    v_max_f32_dpp v10, v10, v10 row_ror:4 row_mask:0xf bank_mask:0xf
    s_nop 1
    v_max_f32_dpp v10, v10, v10 row_ror:8 row_mask:0xf bank_mask:0xf
    v_mov_b32 v11, v10
    s_nop 1
    v_permlane16_swap_b32 v10, v11
    v_max_f32 v10, v10, v11
    v_mov_b32 v11, v10
    s_nop 1
    v_permlane32_swap_b32 v10, v11
    v_max_f32 v10, v10, v11
    v_sub_f32 v8, v8, v10
    v_exp_f32 v8, v8
    s_nop 0
    v_cvt_pk_bf16_f32 v8, v8, v8
    v_and_b32 v10, 0xffff0000, v8
    v_mul_f32 v9, v10, v9
    s_nop 1
    v_add_f32_dpp v9, v9, v9 row_ror:1 row_mask:0xf bank_mask:0xf
    s_nop 1
    v_add_f32_dpp v9, v9, v9 row_ror:2 row_mask:0xf bank_mask:0xf
    s_nop 1
    v_add_f32_dpp v9, v9, v9 row_ror:4 row_mask:0xf bank_mask:0xf
    s_nop 1
    v_add_f32_dpp v9, v9, v9 row_ror:8 row_mask:0xf bank_mask:0xf
    v_mov_b32 v11, v9
    s_nop 1
    v_permlane16_swap_b32 v9, v11
    v_add_f32 v9, v9, v11
    v_mov_b32 v11, v9
    s_nop 1
    v_permlane32_swap_b32 v9, v11
    v_add_f32 v9, v9, v11
    v_rcp_f32 v9, v9
    v_mov_b32_dpp v10, v8 row_newbcast:0 row_mask:0xf bank_mask:0x3
    s_nop 1
    v_mov_b32_dpp v10, v8 row_newbcast:8 row_mask:0xf bank_mask:0xc
    v_and_b32 v84, v10, v4
    v_and_b32 v85, v10, v5
    v_and_b32 v86, v10, v6
    v_and_b32 v87, v10, v7
    s_waitcnt vmcnt(7)
    s_nop 0
    v_mfma_f32_16x16x32_bf16 v[80:83], v[160:163], v[84:87], 0
    v_mov_b32_dpp v10, v8 row_newbcast:1 row_mask:0xf bank_mask:0x3
    s_nop 1
    v_mov_b32_dpp v10, v8 row_newbcast:9 row_mask:0xf bank_mask:0xc
    v_and_b32 v88, v10, v4
    v_and_b32 v89, v10, v5
    v_and_b32 v90, v10, v6
    v_and_b32 v91, v10, v7
    s_waitcnt vmcnt(6)
    s_nop 0
    v_mfma_f32_16x16x32_bf16 v[80:83], v[164:167], v[88:91], v[80:83]
    v_mov_b32_dpp v10, v8 row_newbcast:2 row_mask:0xf bank_mask:0x3
    s_nop 1
    v_mov_b32_dpp v10, v8 row_newbcast:10 row_mask:0xf bank_mask:0xc
    v_and_b32 v84, v10, v4
    v_and_b32 v85, v10, v5
    v_and_b32 v86, v10, v6
    v_and_b32 v87, v10, v7
    s_waitcnt vmcnt(5)
    s_nop 0
    v_mfma_f32_16x16x32_bf16 v[80:83], v[168:171], v[84:87], v[80:83]
    v_mov_b32_dpp v10, v8 row_newbcast:3 row_mask:0xf bank_mask:0x3
    s_nop 1
    v_mov_b32_dpp v10, v8 row_newbcast:11 row_mask:0xf bank_mask:0xc
    v_and_b32 v88, v10, v4
    v_and_b32 v89, v10, v5
    v_and_b32 v90, v10, v6
    v_and_b32 v91, v10, v7
    s_waitcnt vmcnt(4)
    s_nop 0
    v_mfma_f32_16x16x32_bf16 v[80:83], v[172:175], v[88:91], v[80:83]
    v_mov_b32_dpp v10, v8 row_newbcast:4 row_mask:0xf bank_mask:0x3
    s_nop 1
    v_mov_b32_dpp v10, v8 row_newbcast:12 row_mask:0xf bank_mask:0xc
    v_and_b32 v84, v10, v4
    v_and_b32 v85, v10, v5
    v_and_b32 v86, v10, v6
    v_and_b32 v87, v10, v7
    s_waitcnt vmcnt(3)
    s_nop 0
    v_mfma_f32_16x16x32_bf16 v[80:83], v[176:179], v[84:87], v[80:83]
    v_mov_b32_dpp v10, v8 row_newbcast:5 row_mask:0xf bank_mask:0x3
    s_nop 1
    v_mov_b32_dpp v10, v8 row_newbcast:13 row_mask:0xf bank_mask:0xc
    v_and_b32 v88, v10, v4
    v_and_b32 v89, v10, v5
    v_and_b32 v90, v10, v6
    v_and_b32 v91, v10, v7
    s_waitcnt vmcnt(2)
    s_nop 0
    v_mfma_f32_16x16x32_bf16 v[80:83], v[180:183], v[88:91], v[80:83]
    v_mov_b32_dpp v10, v8 row_newbcast:6 row_mask:0xf bank_mask:0x3
    s_nop 1
    v_mov_b32_dpp v10, v8 row_newbcast:14 row_mask:0xf bank_mask:0xc
    v_and_b32 v84, v10, v4
    v_and_b32 v85, v10, v5
    v_and_b32 v86, v10, v6
    v_and_b32 v87, v10, v7
    s_waitcnt vmcnt(1)
    s_nop 0
    v_mfma_f32_16x16x32_bf16 v[80:83], v[184:187], v[84:87], v[80:83]
    v_mov_b32_dpp v10, v8 row_newbcast:7 row_mask:0xf bank_mask:0x3
    s_nop 1
    v_mov_b32_dpp v10, v8 row_newbcast:15 row_mask:0xf bank_mask:0xc
    v_and_b32 v88, v10, v4
    v_and_b32 v89, v10, v5
    v_and_b32 v90, v10, v6
    v_and_b32 v91, v10, v7
    s_waitcnt vmcnt(0)
    s_nop 0
    v_mfma_f32_16x16x32_bf16 v[80:83], v[188:191], v[88:91], v[80:83]
    v_lshl_add_u32 v10, v2, 7, v1
    v_and_b32 v11, 7, v0
    v_lshl_add_u32 v10, v11, 2, v10
    v_lshrrev_b32 v11, 3, v3
    v_lshrrev_b32 v12, 1, v2
    v_cmp_eq_u32 vcc, v11, v12
    s_nop 0
    s_mov_b64 exec, vcc
    ds_write_b32 v10, v80 offset:2048
    ds_write_b32 v10, v81 offset:2080
    ds_write_b32 v10, v82 offset:2112
    ds_write_b32 v10, v83 offset:2144
    s_mov_b64 exec, -1
    v_and_b32 v10, 7, v3
    v_lshl_add_u32 v10, v10, 1, v11
    v_lshl_add_u32 v10, v10, 2, v2
    v_lshl_add_u32 v10, v10, 2, v1
    s_waitcnt lgkmcnt(0)
    ds_read_b32 v11, v10 offset:2048
    ds_read_b32 v12, v10 offset:2304
    s_waitcnt lgkmcnt(0)
    v_add_f32 v11, v11, v12
    v_mul_f32 v11, v11, v9
    v_cvt_pk_bf16_f32 v9, v11, v11
    s_nop 1
    v_and_b32_dpp v84, v9, v4 row_newbcast:0 row_mask:0xf bank_mask:0xf
    v_and_b32_dpp v85, v9, v5 row_newbcast:0 row_mask:0xf bank_mask:0xf
    v_and_b32_dpp v86, v9, v6 row_newbcast:0 row_mask:0xf bank_mask:0xf
    v_and_b32_dpp v87, v9, v7 row_newbcast:0 row_mask:0xf bank_mask:0xf
    s_nop 1
    v_mfma_f32_16x16x32_bf16 v[80:83], v[96:99], v[84:87], 0
    v_and_b32_dpp v88, v9, v4 row_newbcast:1 row_mask:0xf bank_mask:0xf
    v_and_b32_dpp v89, v9, v5 row_newbcast:1 row_mask:0xf bank_mask:0xf
    v_and_b32_dpp v90, v9, v6 row_newbcast:1 row_mask:0xf bank_mask:0xf
    v_and_b32_dpp v91, v9, v7 row_newbcast:1 row_mask:0xf bank_mask:0xf
    s_nop 1
    v_mfma_f32_16x16x32_bf16 v[80:83], v[100:103], v[88:91], v[80:83]
    v_and_b32_dpp v84, v9, v4 row_newbcast:2 row_mask:0xf bank_mask:0xf
    v_and_b32_dpp v85, v9, v5 row_newbcast:2 row_mask:0xf bank_mask:0xf
    v_and_b32_dpp v86, v9, v6 row_newbcast:2 row_mask:0xf bank_mask:0xf
    v_and_b32_dpp v87, v9, v7 row_newbcast:2 row_mask:0xf bank_mask:0xf
    s_nop 1
    v_mfma_f32_16x16x32_bf16 v[80:83], v[104:107], v[84:87], v[80:83]
    v_and_b32_dpp v88, v9, v4 row_newbcast:3 row_mask:0xf bank_mask:0xf
    v_and_b32_dpp v89, v9, v5 row_newbcast:3 row_mask:0xf bank_mask:0xf
    v_and_b32_dpp v90, v9, v6 row_newbcast:3 row_mask:0xf bank_mask:0xf
    v_and_b32_dpp v91, v9, v7 row_newbcast:3 row_mask:0xf bank_mask:0xf
    s_nop 1
    v_mfma_f32_16x16x32_bf16 v[80:83], v[108:111], v[88:91], v[80:83]
    v_and_b32_dpp v84, v9, v4 row_newbcast:4 row_mask:0xf bank_mask:0xf
    v_and_b32_dpp v85, v9, v5 row_newbcast:4 row_mask:0xf bank_mask:0xf
    v_and_b32_dpp v86, v9, v6 row_newbcast:4 row_mask:0xf bank_mask:0xf
    v_and_b32_dpp v87, v9, v7 row_newbcast:4 row_mask:0xf bank_mask:0xf
    s_nop 1
    v_mfma_f32_16x16x32_bf16 v[80:83], v[112:115], v[84:87], v[80:83]
    v_and_b32_dpp v88, v9, v4 row_newbcast:5 row_mask:0xf bank_mask:0xf
    v_and_b32_dpp v89, v9, v5 row_newbcast:5 row_mask:0xf bank_mask:0xf
    v_and_b32_dpp v90, v9, v6 row_newbcast:5 row_mask:0xf bank_mask:0xf
    v_and_b32_dpp v91, v9, v7 row_newbcast:5 row_mask:0xf bank_mask:0xf
    s_nop 1
    v_mfma_f32_16x16x32_bf16 v[80:83], v[116:119], v[88:91], v[80:83]
    v_and_b32_dpp v84, v9, v4 row_newbcast:6 row_mask:0xf bank_mask:0xf
    v_and_b32_dpp v85, v9, v5 row_newbcast:6 row_mask:0xf bank_mask:0xf
    v_and_b32_dpp v86, v9, v6 row_newbcast:6 row_mask:0xf bank_mask:0xf
    v_and_b32_dpp v87, v9, v7 row_newbcast:6 row_mask:0xf bank_mask:0xf
    s_nop 1
    v_mfma_f32_16x16x32_bf16 v[80:83], v[120:123], v[84:87], v[80:83]
    v_and_b32_dpp v88, v9, v4 row_newbcast:7 row_mask:0xf bank_mask:0xf
    v_and_b32_dpp v89, v9, v5 row_newbcast:7 row_mask:0xf bank_mask:0xf
    v_and_b32_dpp v90, v9, v6 row_newbcast:7 row_mask:0xf bank_mask:0xf
    v_and_b32_dpp v91, v9, v7 row_newbcast:7 row_mask:0xf bank_mask:0xf
    s_nop 1
    v_mfma_f32_16x16x32_bf16 v[80:83], v[124:127], v[88:91], v[80:83]
    v_and_b32_dpp v84, v9, v4 row_newbcast:8 row_mask:0xf bank_mask:0xf
    v_and_b32_dpp v85, v9, v5 row_newbcast:8 row_mask:0xf bank_mask:0xf
    v_and_b32_dpp v86, v9, v6 row_newbcast:8 row_mask:0xf bank_mask:0xf
    v_and_b32_dpp v87, v9, v7 row_newbcast:8 row_mask:0xf bank_mask:0xf
    s_nop 1
    v_mfma_f32_16x16x32_bf16 v[80:83], v[128:131], v[84:87], v[80:83]
    v_and_b32_dpp v88, v9, v4 row_newbcast:9 row_mask:0xf bank_mask:0xf
    v_and_b32_dpp v89, v9, v5 row_newbcast:9 row_mask:0xf bank_mask:0xf
    v_and_b32_dpp v90, v9, v6 row_newbcast:9 row_mask:0xf bank_mask:0xf
    v_and_b32_dpp v91, v9, v7 row_newbcast:9 row_mask:0xf bank_mask:0xf
    s_nop 1
    v_mfma_f32_16x16x32_bf16 v[80:83], v[132:135], v[88:91], v[80:83]
    v_and_b32_dpp v84, v9, v4 row_newbcast:10 row_mask:0xf bank_mask:0xf
    v_and_b32_dpp v85, v9, v5 row_newbcast:10 row_mask:0xf bank_mask:0xf
    v_and_b32_dpp v86, v9, v6 row_newbcast:10 row_mask:0xf bank_mask:0xf
    v_and_b32_dpp v87, v9, v7 row_newbcast:10 row_mask:0xf bank_mask:0xf
    s_nop 1
    v_mfma_f32_16x16x32_bf16 v[80:83], v[136:139], v[84:87], v[80:83]
    v_and_b32_dpp v88, v9, v4 row_newbcast:11 row_mask:0xf bank_mask:0xf
    v_and_b32_dpp v89, v9, v5 row_newbcast:11 row_mask:0xf bank_mask:0xf
    v_and_b32_dpp v90, v9, v6 row_newbcast:11 row_mask:0xf bank_mask:0xf
    v_and_b32_dpp v91, v9, v7 row_newbcast:11 row_mask:0xf bank_mask:0xf
    s_nop 1
    v_mfma_f32_16x16x32_bf16 v[80:83], v[140:143], v[88:91], v[80:83]
    v_and_b32_dpp v84, v9, v4 row_newbcast:12 row_mask:0xf bank_mask:0xf
    v_and_b32_dpp v85, v9, v5 row_newbcast:12 row_mask:0xf bank_mask:0xf
    v_and_b32_dpp v86, v9, v6 row_newbcast:12 row_mask:0xf bank_mask:0xf
    v_and_b32_dpp v87, v9, v7 row_newbcast:12 row_mask:0xf bank_mask:0xf
    s_nop 1
    v_mfma_f32_16x16x32_bf16 v[80:83], v[144:147], v[84:87], v[80:83]
    v_and_b32_dpp v88, v9, v4 row_newbcast:13 row_mask:0xf bank_mask:0xf
    v_and_b32_dpp v89, v9, v5 row_newbcast:13 row_mask:0xf bank_mask:0xf
    v_and_b32_dpp v90, v9, v6 row_newbcast:13 row_mask:0xf bank_mask:0xf
    v_and_b32_dpp v91, v9, v7 row_newbcast:13 row_mask:0xf bank_mask:0xf
    s_nop 1
    v_mfma_f32_16x16x32_bf16 v[80:83], v[148:151], v[88:91], v[80:83]
    v_and_b32_dpp v84, v9, v4 row_newbcast:14 row_mask:0xf bank_mask:0xf
    v_and_b32_dpp v85, v9, v5 row_newbcast:14 row_mask:0xf bank_mask:0xf
    v_and_b32_dpp v86, v9, v6 row_newbcast:14 row_mask:0xf bank_mask:0xf
    v_and_b32_dpp v87, v9, v7 row_newbcast:14 row_mask:0xf bank_mask:0xf
    s_nop 1
    v_mfma_f32_16x16x32_bf16 v[80:83], v[152:155], v[84:87], v[80:83]
    v_and_b32_dpp v88, v9, v4 row_newbcast:15 row_mask:0xf bank_mask:0xf
    v_and_b32_dpp v89, v9, v5 row_newbcast:15 row_mask:0xf bank_mask:0xf
    v_and_b32_dpp v90, v9, v6 row_newbcast:15 row_mask:0xf bank_mask:0xf
    v_and_b32_dpp v91, v9, v7 row_newbcast:15 row_mask:0xf bank_mask:0xf
    s_nop 1
    v_mfma_f32_16x16x32_bf16 v[80:83], v[156:159], v[88:91], v[80:83]
    s_mul_i32 s6, s5, 0x300
    s_add_u32 s7, s6, 0x2800
    v_lshl_add_u32 v12, v2, 3, v3
    v_lshlrev_b32 v12, 3, v12
    v_add_u32 v12, s7, v12
    v_mov_b32 v11, 0x40000000
    v_cmp_gt_u32 vcc, 8, v3
    s_nop 1
    v_cndmask_b32 v12, v11, v12, vcc
    v_cvt_pk_bf16_f32 v16, v80, v81
    v_cvt_pk_bf16_f32 v17, v82, v83
    v_min_u32 v16, -2, v16
    v_min_u32 v17, -2, v17
    s_add_u32 s7, s7, 256
    s_mov_b32 s6, 0x3e000000
    v_writelane_b32 v12, s7, 8
    v_writelane_b32 v16, 0, 8
    v_writelane_b32 v17, s6, 8
    buffer_store_dwordx2 v[16:17], v12, s[44:47], 0 offen sc1
    s_branch L_TAIL

L_W1:
    v_and_b32 v11, 3, v0
    v_lshl_add_u32 v11, v2, 2, v11
    v_lshl_add_u32 v11, v11, 4, v1
    ds_read_b128 v[16:19], v11 offset:512
    v_lshrrev_b32 v11, 2, v3
    s_waitcnt lgkmcnt(0)
    v_cmp_eq_u32 vcc, 0, v11
    s_nop 1
    v_cndmask_b32 v176, 0, v16, vcc
    v_cndmask_b32 v177, 0, v17, vcc
    v_cndmask_b32 v178, 0, v18, vcc
    v_cndmask_b32 v179, 0, v19, vcc
    v_cmp_eq_u32 vcc, 1, v11
    s_nop 1
    v_cndmask_b32 v180, 0, v16, vcc
    v_cndmask_b32 v181, 0, v17, vcc
    v_cndmask_b32 v182, 0, v18, vcc
    v_cndmask_b32 v183, 0, v19, vcc
    v_cmp_eq_u32 vcc, 2, v11
    s_nop 1
    v_cndmask_b32 v184, 0, v16, vcc
    v_cndmask_b32 v185, 0, v17, vcc
    v_cndmask_b32 v186, 0, v18, vcc
    v_cndmask_b32 v187, 0, v19, vcc
    v_cmp_eq_u32 vcc, 3, v11
    s_nop 1
    v_cndmask_b32 v188, 0, v16, vcc
    v_cndmask_b32 v189, 0, v17, vcc
    v_cndmask_b32 v190, 0, v18, vcc
    v_cndmask_b32 v191, 0, v19, vcc
    v_mfma_f32_16x16x32_bf16 v[192:195], v[96:99], v[176:179], 0
    v_mfma_f32_16x16x32_bf16 v[196:199], v[100:103], v[176:179], 0
    v_mfma_f32_16x16x32_bf16 v[200:203], v[104:107], v[176:179], 0
    v_mfma_f32_16x16x32_bf16 v[204:207], v[108:111], v[176:179], 0
    v_mfma_f32_16x16x32_bf16 v[192:195], v[112:115], v[180:183], v[192:195]
    v_mfma_f32_16x16x32_bf16 v[196:199], v[116:119], v[180:183], v[196:199]
    v_mfma_f32_16x16x32_bf16 v[200:203], v[120:123], v[180:183], v[200:203]
    v_mfma_f32_16x16x32_bf16 v[204:207], v[124:127], v[180:183], v[204:207]
    v_mfma_f32_16x16x32_bf16 v[192:195], v[128:131], v[184:187], v[192:195]
    v_mfma_f32_16x16x32_bf16 v[196:199], v[132:135], v[184:187], v[196:199]
    v_mfma_f32_16x16x32_bf16 v[200:203], v[136:139], v[184:187], v[200:203]
    v_mfma_f32_16x16x32_bf16 v[204:207], v[140:143], v[184:187], v[204:207]
    v_mfma_f32_16x16x32_bf16 v[192:195], v[144:147], v[188:191], v[192:195]
    v_mfma_f32_16x16x32_bf16 v[196:199], v[148:151], v[188:191], v[196:199]
    v_mfma_f32_16x16x32_bf16 v[200:203], v[152:155], v[188:191], v[200:203]
    v_mfma_f32_16x16x32_bf16 v[204:207], v[156:159], v[188:191], v[204:207]
    v_lshrrev_b32 v12, 2, v0
    v_lshlrev_b32 v12, 3, v12
    s_add_u32 s6, s55, 0x2400
    v_add_u32 v12, s6, v12
    v_and_b32 v11, 3, v0
    v_cmp_eq_u32 vcc, 0, v11
    v_mov_b32 v11, 0x40000000
    s_nop 0
    v_cndmask_b32 v12, v11, v12, vcc
    v_mov_b32_dpp v16, v192 quad_perm:[0,0,0,0] row_mask:0xf bank_mask:0xf
    s_nop 1
    v_add_f32_dpp v16, v193, v16 quad_perm:[1,1,1,1] row_mask:0xf bank_mask:0xf
    s_nop 1
    v_add_f32_dpp v16, v194, v16 quad_perm:[2,2,2,2] row_mask:0xf bank_mask:0xf
    s_nop 1
    v_add_f32_dpp v16, v195, v16 quad_perm:[3,3,3,3] row_mask:0xf bank_mask:0xf
    v_mov_b32_dpp v17, v196 quad_perm:[0,0,0,0] row_mask:0xf bank_mask:0xf
    s_nop 1
    v_add_f32_dpp v17, v197, v17 quad_perm:[1,1,1,1] row_mask:0xf bank_mask:0xf
    s_nop 1
    v_add_f32_dpp v17, v198, v17 quad_perm:[2,2,2,2] row_mask:0xf bank_mask:0xf
    s_nop 1
    v_add_f32_dpp v17, v199, v17 quad_perm:[3,3,3,3] row_mask:0xf bank_mask:0xf
    v_mov_b32_dpp v18, v200 quad_perm:[0,0,0,0] row_mask:0xf bank_mask:0xf
    s_nop 1
    v_add_f32_dpp v18, v201, v18 quad_perm:[1,1,1,1] row_mask:0xf bank_mask:0xf
    s_nop 1
    v_add_f32_dpp v18, v202, v18 quad_perm:[2,2,2,2] row_mask:0xf bank_mask:0xf
    s_nop 1
    v_add_f32_dpp v18, v203, v18 quad_perm:[3,3,3,3] row_mask:0xf bank_mask:0xf
    v_mov_b32_dpp v19, v204 quad_perm:[0,0,0,0] row_mask:0xf bank_mask:0xf
    s_nop 1
    v_add_f32_dpp v19, v205, v19 quad_perm:[1,1,1,1] row_mask:0xf bank_mask:0xf
    s_nop 1
    v_add_f32_dpp v19, v206, v19 quad_perm:[2,2,2,2] row_mask:0xf bank_mask:0xf
    s_nop 1
    v_add_f32_dpp v19, v207, v19 quad_perm:[3,3,3,3] row_mask:0xf bank_mask:0xf
    v_cvt_pk_bf16_f32 v16, v16, v17
    v_cvt_pk_bf16_f32 v17, v18, v19
    v_min_u32 v16, -2, v16
    v_min_u32 v17, -2, v17
    buffer_store_dwordx2 v[16:17], v12, s[44:47], 0 offen sc1
    s_mov_b32 s58, 1
    s_atomic_add s58, s[68:69], 0x2080 glc
    v_lshlrev_b32 v14, 2, v0
L_rc_6:
    v_cmp_eq_u32 vcc, 0, v15
    s_nop 0
    s_cmp_eq_u64 vcc, 0
    s_cbranch_scc1 L_rcd_7
    global_load_dword v15, v14, s[40:41] sc1
    s_waitcnt vmcnt(0)
    s_add_u32 s52, s52, 1
    s_cmp_lt_u32 s52, 400000
    s_cbranch_scc1 L_rc_6
L_rcd_7:
    v_lshlrev_b32 v18, 8, v0
    v_add_u32 v18, 0x384040, v18
    v_mov_b32 v19, 1
    s_waitcnt lgkmcnt(0)
    s_cmp_eq_u32 s58, 6
    s_cbranch_scc0 L_W1_nl
    s_mov_b64 exec, 0xff
    buffer_atomic_add v19, v18, s[48:51], 0 offen sc1
    s_mov_b64 exec, -1
L_W1_nl:
    s_mov_b32 s4, s70
    s_mov_b32 s5, s71
    s_mul_i32 s6, s4, 0x5300
    s_add_u32 s44, s42, s6
    s_addc_u32 s45, s43, 0
    s_mov_b32 s46, 0x5200
    s_mov_b32 s47, 0x20000
    s_mov_b32 s48, s42
    s_mov_b32 s49, s43
    s_mov_b32 s50, 0x400000
    s_mov_b32 s51, 0x20000
    s_lshl_b32 s6, s4, 8
    s_add_u32 s6, s6, 0x380000
    s_add_u32 s68, s42, s6
    s_addc_u32 s69, s43, 0

L_TAIL:
    s_sub_u32 s56, 2, s3
    s_lshl_b32 s57, s3, 14
    s_mul_i32 s58, s3, 0x180
    v_and_b32 v10, 7, v0
    s_add_u32 s6, s58, 0x2800
    v_mul_u32_u24 v73, 0x300, v10
    v_add_u32 v73, s6, v73
    v_lshl_add_u32 v72, v2, 4, v73
    v_mov_b32 v12, 0x40000000
    v_cmp_gt_u32 vcc, 8, v3
    s_nop 1
    v_cndmask_b32 v72, v12, v72, vcc
    v_lshrrev_b32 v11, 2, v3
    v_and_b32 v9, 3, v3
    v_lshlrev_b32 v68, 10, v11
    v_lshl_add_u32 v68, v2, 8, v68
    v_lshl_add_u32 v68, v9, 3, v68
    v_add_u32 v68, s57, v68
    v_lshl_add_u32 v68, v11, 5, v68
    v_xor_b32 v69, 32, v68
    v_xor_b32 v70, 64, v68
    v_xor_b32 v71, 96, v68
    s_lshl_b32 s6, s3, 14
    s_lshl_b32 s7, s5, 11
    s_add_u32 s6, s6, s7
    s_add_u32 s60, s6, 0x3a0000
    v_lshlrev_b32 v74, 8, v2
    v_and_b32 v77, 8, v0
    v_add_u32 v77, v74, v77
    v_and_b32 v11, 1, v0
    v_lshl_add_u32 v77, v11, 2, v77
    v_cmp_lt_u32 vcc, 5, v10
    s_nop 1
    v_cndmask_b32 v77, v12, v77, vcc
    v_lshl_add_u32 v74, v3, 2, v74
    v_cmp_eq_u32 s[62:63], 7, v10
    s_lshl_b32 s6, s5, 7
    s_lshl_b32 s7, s3, 10
    s_add_u32 s6, s6, s7
    v_lshlrev_b32 v78, 1, v0
    v_add_u32 v78, s6, v78
    v_mov_b32 v76, 0x41f80000
    s_mov_b32 s8, s38
    s_mov_b32 s9, s39
    s_mov_b32 s10, 0x800
    s_mov_b32 s11, 0x20000
    s_mov_b32 s59, 0
L_lw_8:
    ds_read_b32 v11, v1 offset:24
    s_waitcnt lgkmcnt(0)
    v_readfirstlane_b32 s6, v11
    s_nop 0
    s_cmp_ge_u32 s6, 1
    s_cbranch_scc1 L_lwd_9
    s_sleep 8
    s_add_u32 s52, s52, 1
    s_cmp_lt_u32 s52, 400000
    s_cbranch_scc1 L_lw_8
L_lwd_9:
L_lw_10:
    ds_read_b32 v11, v1 offset:28
    s_waitcnt lgkmcnt(0)
    v_readfirstlane_b32 s6, v11
    s_nop 0
    s_cmp_ge_u32 s6, 4
    s_cbranch_scc1 L_lwd_11
    s_sleep 2
    s_add_u32 s52, s52, 1
    s_cmp_lt_u32 s52, 400000
    s_cbranch_scc1 L_lw_10
L_lwd_11:
    s_cmp_eq_u32 s3, 0
    s_cbranch_scc1 L_T2
L_lw_12:
    ds_read_b32 v11, v1 offset:36
    s_waitcnt lgkmcnt(0)
    v_readfirstlane_b32 s6, v11
    s_nop 0
    s_cmp_ge_u32 s6, 1
    s_cbranch_scc1 L_lwd_13
    s_add_u32 s52, s52, 1
    s_cmp_lt_u32 s52, 400000
    s_cbranch_scc1 L_lw_12
L_lwd_13:

L_T2:
    buffer_load_dwordx2 v[32:33], v73, s[44:47], 0 offen offset:256 sc1
    buffer_load_dwordx4 v[16:19], v72, s[44:47], 0 offen offset:0 sc1
    buffer_load_dwordx4 v[20:23], v72, s[44:47], 0 offen offset:64 sc1
    buffer_load_dwordx4 v[24:27], v72, s[44:47], 0 offen offset:128 sc1
    buffer_load_dwordx4 v[28:31], v72, s[44:47], 0 offen offset:192 sc1
    s_mov_b64 s[72:73], exec
    s_mov_b64 exec, -1
    ds_read_b128 v[80:83], v1 offset:48
    s_waitcnt lgkmcnt(0)
    v_readfirstlane_b32 s74, v80
    v_readfirstlane_b32 s75, v81
    v_readfirstlane_b32 s76, v82
    v_readfirstlane_b32 s77, v83
    s_cmp_gt_u32 s59, 0
    s_cbranch_scc1 L_an_15
    s_cmp_lt_u32 s74, s56
    s_cbranch_scc1 L_ad_14
    ds_read_b64_tr_b16 v[96:97], v68 offset:0
    ds_read_b64_tr_b16 v[98:99], v68 offset:128
    ds_read_b64_tr_b16 v[100:101], v69 offset:0
    ds_read_b64_tr_b16 v[102:103], v69 offset:128
    ds_read_b64_tr_b16 v[104:105], v70 offset:0
    ds_read_b64_tr_b16 v[106:107], v70 offset:128
    ds_read_b64_tr_b16 v[108:109], v71 offset:0
    ds_read_b64_tr_b16 v[110:111], v71 offset:128
    s_mov_b32 s59, 1
L_an_15:
    s_cmp_gt_u32 s59, 1
    s_cbranch_scc1 L_an_16
    s_cmp_lt_u32 s75, s56
    s_cbranch_scc1 L_ad_14
    s_waitcnt lgkmcnt(6)
    ds_read_b64_tr_b16 v[112:113], v68 offset:4096
    ds_read_b64_tr_b16 v[114:115], v68 offset:4224
    ds_read_b64_tr_b16 v[116:117], v69 offset:4096
    ds_read_b64_tr_b16 v[118:119], v69 offset:4224
    ds_read_b64_tr_b16 v[120:121], v70 offset:4096
    ds_read_b64_tr_b16 v[122:123], v70 offset:4224
    ds_read_b64_tr_b16 v[124:125], v71 offset:4096
    ds_read_b64_tr_b16 v[126:127], v71 offset:4224
    s_mov_b32 s59, 2
L_an_16:
    s_cmp_gt_u32 s59, 2
    s_cbranch_scc1 L_an_17
    s_cmp_lt_u32 s76, s56
    s_cbranch_scc1 L_ad_14
    s_waitcnt lgkmcnt(6)
    ds_read_b64_tr_b16 v[128:129], v68 offset:8192
    ds_read_b64_tr_b16 v[130:131], v68 offset:8320
    ds_read_b64_tr_b16 v[132:133], v69 offset:8192
    ds_read_b64_tr_b16 v[134:135], v69 offset:8320
    ds_read_b64_tr_b16 v[136:137], v70 offset:8192
    ds_read_b64_tr_b16 v[138:139], v70 offset:8320
    ds_read_b64_tr_b16 v[140:141], v71 offset:8192
    ds_read_b64_tr_b16 v[142:143], v71 offset:8320
    s_mov_b32 s59, 3
L_an_17:
    s_cmp_gt_u32 s59, 3
    s_cbranch_scc1 L_an_18
    s_cmp_lt_u32 s77, s56
    s_cbranch_scc1 L_ad_14
    s_waitcnt lgkmcnt(6)
    ds_read_b64_tr_b16 v[144:145], v68 offset:12288
    ds_read_b64_tr_b16 v[146:147], v68 offset:12416
    ds_read_b64_tr_b16 v[148:149], v69 offset:12288
    ds_read_b64_tr_b16 v[150:151], v69 offset:12416
    ds_read_b64_tr_b16 v[152:153], v70 offset:12288
    ds_read_b64_tr_b16 v[154:155], v70 offset:12416
    ds_read_b64_tr_b16 v[156:157], v71 offset:12288
    ds_read_b64_tr_b16 v[158:159], v71 offset:12416
    s_mov_b32 s59, 4
L_an_18:
L_ad_14:
    s_waitcnt vmcnt(0) lgkmcnt(0)
    ds_read_b128 v[80:83], v1 offset:48
    s_mov_b64 exec, s[72:73]
    v_max_u32 v11, v16, v17
    v_max3_u32 v11, v18, v19, v11
    v_max3_u32 v11, v20, v21, v11
    v_max3_u32 v11, v22, v23, v11
    v_max3_u32 v11, v24, v25, v11
    v_max3_u32 v11, v26, v27, v11
    v_max3_u32 v11, v28, v29, v11
    v_max3_u32 v11, v30, v31, v11
    v_max3_u32 v11, v32, v33, v11
    v_cmp_eq_u32 vcc, -1, v11
    s_nop 0
    s_and_b64 vcc, vcc, exec
    s_cbranch_scc0 L_T2v
    s_mov_b64 exec, vcc
    s_add_u32 s52, s52, 1
    s_cmp_lt_u32 s52, 400000
    s_cbranch_scc1 L_T2
L_T2v:
    s_mov_b64 exec, -1
    s_mov_b32 s79, s59
    s_cmp_eq_u32 s59, 4
    s_cbranch_scc1 L_T2m0
    s_waitcnt lgkmcnt(0)
    v_readfirstlane_b32 s74, v80
    v_readfirstlane_b32 s75, v81
    v_readfirstlane_b32 s76, v82
    v_readfirstlane_b32 s77, v83
    s_cmp_gt_u32 s59, 0
    s_cbranch_scc1 L_an_20
    s_cmp_lt_u32 s74, s56
    s_cbranch_scc1 L_ad_19
    ds_read_b64_tr_b16 v[96:97], v68 offset:0
    ds_read_b64_tr_b16 v[98:99], v68 offset:128
    ds_read_b64_tr_b16 v[100:101], v69 offset:0
    ds_read_b64_tr_b16 v[102:103], v69 offset:128
    ds_read_b64_tr_b16 v[104:105], v70 offset:0
    ds_read_b64_tr_b16 v[106:107], v70 offset:128
    ds_read_b64_tr_b16 v[108:109], v71 offset:0
    ds_read_b64_tr_b16 v[110:111], v71 offset:128
    s_mov_b32 s59, 1
L_an_20:
    s_cmp_gt_u32 s59, 1
    s_cbranch_scc1 L_an_21
    s_cmp_lt_u32 s75, s56
    s_cbranch_scc1 L_ad_19
    s_waitcnt lgkmcnt(6)
    ds_read_b64_tr_b16 v[112:113], v68 offset:4096
    ds_read_b64_tr_b16 v[114:115], v68 offset:4224
    ds_read_b64_tr_b16 v[116:117], v69 offset:4096
    ds_read_b64_tr_b16 v[118:119], v69 offset:4224
    ds_read_b64_tr_b16 v[120:121], v70 offset:4096
    ds_read_b64_tr_b16 v[122:123], v70 offset:4224
    ds_read_b64_tr_b16 v[124:125], v71 offset:4096
    ds_read_b64_tr_b16 v[126:127], v71 offset:4224
    s_mov_b32 s59, 2
L_an_21:
    s_cmp_gt_u32 s59, 2
    s_cbranch_scc1 L_an_22
    s_cmp_lt_u32 s76, s56
    s_cbranch_scc1 L_ad_19
    s_waitcnt lgkmcnt(6)
    ds_read_b64_tr_b16 v[128:129], v68 offset:8192
    ds_read_b64_tr_b16 v[130:131], v68 offset:8320
    ds_read_b64_tr_b16 v[132:133], v69 offset:8192
    ds_read_b64_tr_b16 v[134:135], v69 offset:8320
    ds_read_b64_tr_b16 v[136:137], v70 offset:8192
    ds_read_b64_tr_b16 v[138:139], v70 offset:8320
    ds_read_b64_tr_b16 v[140:141], v71 offset:8192
    ds_read_b64_tr_b16 v[142:143], v71 offset:8320
    s_mov_b32 s59, 3
L_an_22:
    s_cmp_gt_u32 s59, 3
    s_cbranch_scc1 L_an_23
    s_cmp_lt_u32 s77, s56
    s_cbranch_scc1 L_ad_19
    s_waitcnt lgkmcnt(6)
    ds_read_b64_tr_b16 v[144:145], v68 offset:12288
    ds_read_b64_tr_b16 v[146:147], v68 offset:12416
    ds_read_b64_tr_b16 v[148:149], v69 offset:12288
    ds_read_b64_tr_b16 v[150:151], v69 offset:12416
    ds_read_b64_tr_b16 v[152:153], v70 offset:12288
    ds_read_b64_tr_b16 v[154:155], v70 offset:12416
    ds_read_b64_tr_b16 v[156:157], v71 offset:12288
    ds_read_b64_tr_b16 v[158:159], v71 offset:12416
    s_mov_b32 s59, 4
L_an_23:
L_ad_19:
    s_cmp_gt_u32 s79, 0
    s_cbranch_scc1 L_T2m0
    s_cmp_gt_u32 s59, 0
    s_cbranch_scc1 L_tx_25
L_tw_24:
    ds_read_b128 v[80:83], v1 offset:48
    s_waitcnt lgkmcnt(0)
    v_readfirstlane_b32 s74, v80
    v_readfirstlane_b32 s75, v81
    v_readfirstlane_b32 s76, v82
    v_readfirstlane_b32 s77, v83
    s_cmp_gt_u32 s59, 0
    s_cbranch_scc1 L_an_27
    s_cmp_lt_u32 s74, s56
    s_cbranch_scc1 L_ad_26
    ds_read_b64_tr_b16 v[96:97], v68 offset:0
    ds_read_b64_tr_b16 v[98:99], v68 offset:128
    ds_read_b64_tr_b16 v[100:101], v69 offset:0
    ds_read_b64_tr_b16 v[102:103], v69 offset:128
    ds_read_b64_tr_b16 v[104:105], v70 offset:0
    ds_read_b64_tr_b16 v[106:107], v70 offset:128
    ds_read_b64_tr_b16 v[108:109], v71 offset:0
    ds_read_b64_tr_b16 v[110:111], v71 offset:128
    s_mov_b32 s59, 1
L_an_27:
    s_cmp_gt_u32 s59, 1
    s_cbranch_scc1 L_an_28
    s_cmp_lt_u32 s75, s56
    s_cbranch_scc1 L_ad_26
    s_waitcnt lgkmcnt(6)
    ds_read_b64_tr_b16 v[112:113], v68 offset:4096
    ds_read_b64_tr_b16 v[114:115], v68 offset:4224
    ds_read_b64_tr_b16 v[116:117], v69 offset:4096
    ds_read_b64_tr_b16 v[118:119], v69 offset:4224
    ds_read_b64_tr_b16 v[120:121], v70 offset:4096
    ds_read_b64_tr_b16 v[122:123], v70 offset:4224
    ds_read_b64_tr_b16 v[124:125], v71 offset:4096
    ds_read_b64_tr_b16 v[126:127], v71 offset:4224
    s_mov_b32 s59, 2
L_an_28:
    s_cmp_gt_u32 s59, 2
    s_cbranch_scc1 L_an_29
    s_cmp_lt_u32 s76, s56
    s_cbranch_scc1 L_ad_26
    s_waitcnt lgkmcnt(6)
    ds_read_b64_tr_b16 v[128:129], v68 offset:8192
    ds_read_b64_tr_b16 v[130:131], v68 offset:8320
    ds_read_b64_tr_b16 v[132:133], v69 offset:8192
    ds_read_b64_tr_b16 v[134:135], v69 offset:8320
    ds_read_b64_tr_b16 v[136:137], v70 offset:8192
    ds_read_b64_tr_b16 v[138:139], v70 offset:8320
    ds_read_b64_tr_b16 v[140:141], v71 offset:8192
    ds_read_b64_tr_b16 v[142:143], v71 offset:8320
    s_mov_b32 s59, 3
L_an_29:
    s_cmp_gt_u32 s59, 3
    s_cbranch_scc1 L_an_30
    s_cmp_lt_u32 s77, s56
    s_cbranch_scc1 L_ad_26
    s_waitcnt lgkmcnt(6)
    ds_read_b64_tr_b16 v[144:145], v68 offset:12288
    ds_read_b64_tr_b16 v[146:147], v68 offset:12416
    ds_read_b64_tr_b16 v[148:149], v69 offset:12288
    ds_read_b64_tr_b16 v[150:151], v69 offset:12416
    ds_read_b64_tr_b16 v[152:153], v70 offset:12288
    ds_read_b64_tr_b16 v[154:155], v70 offset:12416
    ds_read_b64_tr_b16 v[156:157], v71 offset:12288
    ds_read_b64_tr_b16 v[158:159], v71 offset:12416
    s_mov_b32 s59, 4
L_an_30:
L_ad_26:
    s_cmp_gt_u32 s59, 0
    s_cbranch_scc1 L_tx_25
    s_add_u32 s52, s52, 1
    s_cmp_lt_u32 s52, 400000
    s_cbranch_scc1 L_tw_24
L_tx_25:
    s_waitcnt lgkmcnt(0)
    s_mov_b32 s79, s59
L_T2m0:
    v_mfma_f32_16x16x32_bf16 v[36:39], v[16:19], v[96:99], 0
    v_max_f32_dpp v8, v32, v32 row_ror:1 row_mask:0xf bank_mask:0xf
    v_mfma_f32_16x16x32_bf16 v[40:43], v[16:19], v[100:103], 0
    s_nop 0
    v_max_f32_dpp v8, v8, v8 row_ror:2 row_mask:0xf bank_mask:0xf
    v_mfma_f32_16x16x32_bf16 v[44:47], v[16:19], v[104:107], 0
    s_nop 0
    v_max_f32_dpp v8, v8, v8 row_ror:4 row_mask:0xf bank_mask:0xf
    v_mfma_f32_16x16x32_bf16 v[48:51], v[16:19], v[108:111], 0
    v_sub_f32 v8, v32, v8
    s_cmp_gt_u32 s79, 1
    s_cbranch_scc1 L_T2m1
    s_cmp_gt_u32 s59, 1
    s_cbranch_scc1 L_tx_32
L_tw_31:
    ds_read_b128 v[80:83], v1 offset:48
    s_waitcnt lgkmcnt(0)
    v_readfirstlane_b32 s75, v81
    v_readfirstlane_b32 s76, v82
    v_readfirstlane_b32 s77, v83
    s_cmp_gt_u32 s59, 1
    s_cbranch_scc1 L_an_34
    s_cmp_lt_u32 s75, s56
    s_cbranch_scc1 L_ad_33
    ds_read_b64_tr_b16 v[112:113], v68 offset:4096
    ds_read_b64_tr_b16 v[114:115], v68 offset:4224
    ds_read_b64_tr_b16 v[116:117], v69 offset:4096
    ds_read_b64_tr_b16 v[118:119], v69 offset:4224
    ds_read_b64_tr_b16 v[120:121], v70 offset:4096
    ds_read_b64_tr_b16 v[122:123], v70 offset:4224
    ds_read_b64_tr_b16 v[124:125], v71 offset:4096
    ds_read_b64_tr_b16 v[126:127], v71 offset:4224
    s_mov_b32 s59, 2
L_an_34:
    s_cmp_gt_u32 s59, 2
    s_cbranch_scc1 L_an_35
    s_cmp_lt_u32 s76, s56
    s_cbranch_scc1 L_ad_33
    s_waitcnt lgkmcnt(6)
    ds_read_b64_tr_b16 v[128:129], v68 offset:8192
    ds_read_b64_tr_b16 v[130:131], v68 offset:8320
    ds_read_b64_tr_b16 v[132:133], v69 offset:8192
    ds_read_b64_tr_b16 v[134:135], v69 offset:8320
    ds_read_b64_tr_b16 v[136:137], v70 offset:8192
    ds_read_b64_tr_b16 v[138:139], v70 offset:8320
    ds_read_b64_tr_b16 v[140:141], v71 offset:8192
    ds_read_b64_tr_b16 v[142:143], v71 offset:8320
    s_mov_b32 s59, 3
L_an_35:
    s_cmp_gt_u32 s59, 3
    s_cbranch_scc1 L_an_36
    s_cmp_lt_u32 s77, s56
    s_cbranch_scc1 L_ad_33
    s_waitcnt lgkmcnt(6)
    ds_read_b64_tr_b16 v[144:145], v68 offset:12288
    ds_read_b64_tr_b16 v[146:147], v68 offset:12416
    ds_read_b64_tr_b16 v[148:149], v69 offset:12288
    ds_read_b64_tr_b16 v[150:151], v69 offset:12416
    ds_read_b64_tr_b16 v[152:153], v70 offset:12288
    ds_read_b64_tr_b16 v[154:155], v70 offset:12416
    ds_read_b64_tr_b16 v[156:157], v71 offset:12288
    ds_read_b64_tr_b16 v[158:159], v71 offset:12416
    s_mov_b32 s59, 4
L_an_36:
L_ad_33:
    s_cmp_gt_u32 s59, 1
    s_cbranch_scc1 L_tx_32
    s_add_u32 s52, s52, 1
    s_cmp_lt_u32 s52, 400000
    s_cbranch_scc1 L_tw_31
L_tx_32:
    s_waitcnt lgkmcnt(0)
    s_mov_b32 s79, s59
L_T2m1:
    v_mfma_f32_16x16x32_bf16 v[36:39], v[20:23], v[112:115], v[36:39]
    v_exp_f32 v8, v8
    v_mfma_f32_16x16x32_bf16 v[40:43], v[20:23], v[116:119], v[40:43]
    v_mul_f32 v9, v8, v33
    v_mfma_f32_16x16x32_bf16 v[44:47], v[20:23], v[120:123], v[44:47]
    s_nop 0
    v_add_f32_dpp v9, v9, v9 row_ror:1 row_mask:0xf bank_mask:0xf
    v_mfma_f32_16x16x32_bf16 v[48:51], v[20:23], v[124:127], v[48:51]
    s_nop 0
    v_add_f32_dpp v9, v9, v9 row_ror:2 row_mask:0xf bank_mask:0xf
    s_nop 1
    v_add_f32_dpp v9, v9, v9 row_ror:4 row_mask:0xf bank_mask:0xf
    s_cmp_gt_u32 s79, 2
    s_cbranch_scc1 L_T2m2
    s_cmp_gt_u32 s59, 2
    s_cbranch_scc1 L_tx_38
L_tw_37:
    ds_read_b128 v[80:83], v1 offset:48
    s_waitcnt lgkmcnt(0)
    v_readfirstlane_b32 s76, v82
    v_readfirstlane_b32 s77, v83
    s_cmp_gt_u32 s59, 2
    s_cbranch_scc1 L_an_40
    s_cmp_lt_u32 s76, s56
    s_cbranch_scc1 L_ad_39
    ds_read_b64_tr_b16 v[128:129], v68 offset:8192
    ds_read_b64_tr_b16 v[130:131], v68 offset:8320
    ds_read_b64_tr_b16 v[132:133], v69 offset:8192
    ds_read_b64_tr_b16 v[134:135], v69 offset:8320
    ds_read_b64_tr_b16 v[136:137], v70 offset:8192
    ds_read_b64_tr_b16 v[138:139], v70 offset:8320
    ds_read_b64_tr_b16 v[140:141], v71 offset:8192
    ds_read_b64_tr_b16 v[142:143], v71 offset:8320
    s_mov_b32 s59, 3
L_an_40:
    s_cmp_gt_u32 s59, 3
    s_cbranch_scc1 L_an_41
    s_cmp_lt_u32 s77, s56
    s_cbranch_scc1 L_ad_39
    s_waitcnt lgkmcnt(6)
    ds_read_b64_tr_b16 v[144:145], v68 offset:12288
    ds_read_b64_tr_b16 v[146:147], v68 offset:12416
    ds_read_b64_tr_b16 v[148:149], v69 offset:12288
    ds_read_b64_tr_b16 v[150:151], v69 offset:12416
    ds_read_b64_tr_b16 v[152:153], v70 offset:12288
    ds_read_b64_tr_b16 v[154:155], v70 offset:12416
    ds_read_b64_tr_b16 v[156:157], v71 offset:12288
    ds_read_b64_tr_b16 v[158:159], v71 offset:12416
    s_mov_b32 s59, 4
L_an_41:
L_ad_39:
    s_cmp_gt_u32 s59, 2
    s_cbranch_scc1 L_tx_38
    s_add_u32 s52, s52, 1
    s_cmp_lt_u32 s52, 400000
    s_cbranch_scc1 L_tw_37
L_tx_38:
    s_waitcnt lgkmcnt(0)
    s_mov_b32 s79, s59
L_T2m2:
    v_mfma_f32_16x16x32_bf16 v[36:39], v[24:27], v[128:131], v[36:39]
    v_rcp_f32 v9, v9
    s_nop 0
    v_mul_f32 v8, v8, v9
    v_mfma_f32_16x16x32_bf16 v[40:43], v[24:27], v[132:135], v[40:43]
    s_nop 0
    v_mov_b32_dpp v52, v8 row_newbcast:0 row_mask:0x5 bank_mask:0xf
    v_mov_b32_dpp v53, v8 row_newbcast:1 row_mask:0x5 bank_mask:0xf
    v_mfma_f32_16x16x32_bf16 v[44:47], v[24:27], v[136:139], v[44:47]
    v_mov_b32_dpp v54, v8 row_newbcast:2 row_mask:0x5 bank_mask:0xf
    v_mov_b32_dpp v55, v8 row_newbcast:3 row_mask:0x5 bank_mask:0xf
    v_mfma_f32_16x16x32_bf16 v[48:51], v[24:27], v[140:143], v[48:51]
    s_cmp_gt_u32 s79, 3
    s_cbranch_scc1 L_T2m3
    s_cmp_gt_u32 s59, 3
    s_cbranch_scc1 L_tx_43
L_tw_42:
    ds_read_b128 v[80:83], v1 offset:48
    s_waitcnt lgkmcnt(0)
    v_readfirstlane_b32 s77, v83
    s_cmp_gt_u32 s59, 3
    s_cbranch_scc1 L_an_45
    s_cmp_lt_u32 s77, s56
    s_cbranch_scc1 L_ad_44
    ds_read_b64_tr_b16 v[144:145], v68 offset:12288
    ds_read_b64_tr_b16 v[146:147], v68 offset:12416
    ds_read_b64_tr_b16 v[148:149], v69 offset:12288
    ds_read_b64_tr_b16 v[150:151], v69 offset:12416
    ds_read_b64_tr_b16 v[152:153], v70 offset:12288
    ds_read_b64_tr_b16 v[154:155], v70 offset:12416
    ds_read_b64_tr_b16 v[156:157], v71 offset:12288
    ds_read_b64_tr_b16 v[158:159], v71 offset:12416
    s_mov_b32 s59, 4
L_an_45:
L_ad_44:
    s_cmp_gt_u32 s59, 3
    s_cbranch_scc1 L_tx_43
    s_add_u32 s52, s52, 1
    s_cmp_lt_u32 s52, 400000
    s_cbranch_scc1 L_tw_42
L_tx_43:
    s_waitcnt lgkmcnt(0)
    s_mov_b32 s79, s59
L_T2m3:
    v_mfma_f32_16x16x32_bf16 v[36:39], v[28:31], v[144:147], v[36:39]
    v_mov_b32_dpp v52, v8 row_newbcast:4 row_mask:0xa bank_mask:0xf
    v_mov_b32_dpp v53, v8 row_newbcast:5 row_mask:0xa bank_mask:0xf
    v_mfma_f32_16x16x32_bf16 v[40:43], v[28:31], v[148:151], v[40:43]
    v_mov_b32_dpp v54, v8 row_newbcast:6 row_mask:0xa bank_mask:0xf
    v_mov_b32_dpp v55, v8 row_newbcast:7 row_mask:0xa bank_mask:0xf
    v_mfma_f32_16x16x32_bf16 v[44:47], v[28:31], v[152:155], v[44:47]
    v_mfma_f32_16x16x32_bf16 v[48:51], v[28:31], v[156:159], v[48:51]
L_T2e:
    s_nop 0
    v_mul_f32 v56, v52, v36
    v_fmac_f32 v56, v53, v37
    v_fmac_f32 v56, v54, v38
    v_fmac_f32 v56, v55, v39
    v_mul_f32 v57, v52, v40
    v_fmac_f32 v57, v53, v41
    v_fmac_f32 v57, v54, v42
    v_fmac_f32 v57, v55, v43
    v_mul_f32 v58, v52, v44
    v_fmac_f32 v58, v53, v45
    v_fmac_f32 v58, v54, v46
    v_fmac_f32 v58, v55, v47
    v_mul_f32 v59, v52, v48
    v_fmac_f32 v59, v53, v49
    v_fmac_f32 v59, v54, v50
    v_fmac_f32 v59, v55, v51
    v_permlane16_swap_b32 v56, v57
    s_nop 0
    v_permlane16_swap_b32 v58, v59
    v_add_f32 v56, v56, v57
    v_add_f32 v58, v58, v59
    s_nop 1
    v_permlane32_swap_b32 v56, v58
    v_add_f32 v56, v56, v58
    v_cndmask_b32_e64 v57, v56, 1.0, s[62:63]
    v_cndmask_b32_e64 v58, 1.0, v56, s[62:63]
    buffer_atomic_add_f32 v57, v74, s[48:51], s60 offen sc0 sc1
    buffer_atomic_add_f32 v58, v77, s[48:51], s60 offen offset:1024 sc0 sc1
    s_waitcnt vmcnt(0)
    v_mov_b32_dpp v59, v57 row_newbcast:7 row_mask:0xf bank_mask:0x3
    v_mov_b32_dpp v60, v58 quad_perm:[1,0,3,2] row_mask:0xf bank_mask:0xf
    v_cndmask_b32_e64 v61, v57, v58, s[62:63]
    v_mov_b32_dpp v59, v57 row_newbcast:15 row_mask:0xf bank_mask:0xc
    v_add_f32 v61, v61, v56
    v_cndmask_b32_e64 v59, v59, v60, s[62:63]
    v_cmp_eq_f32 vcc, v59, v76
    v_cvt_pk_bf16_f32 v61, v61, v61
    s_nop 0
    v_cndmask_b32 v78, v12, v78, vcc
    buffer_store_short v61, v78, s[8:11], 0 offen sc1
L_FIN:
    s_endpgm

L_RESET:
    s_mul_i32 s6, s3, 0x1400
    s_mul_i32 s7, s70, 0x5300
    s_add_u32 s6, s6, s7
    v_lshl_add_u32 v85, v0, 4, s6
    v_add_u32 v86, 0x1000, v85
    s_lshl_b32 s6, s70, 8
    s_add_u32 s6, s6, 0x380000
    v_lshl_add_u32 v84, v2, 13, s6
    v_lshl_add_u32 v84, v3, 4, v84
    s_cmp_eq_u32 s3, 0
    s_cselect_b64 vcc, -1, 0
    v_mov_b32 v88, -1
    v_mov_b32 v89, -1
    v_mov_b32 v90, -1
    v_mov_b32 v91, -1
    v_cndmask_b32 v84, v86, v84, vcc
    s_waitcnt lgkmcnt(0)
    global_store_dwordx4 v85, v[88:91], s[42:43] offset:0 sc1
    global_store_dwordx4 v85, v[88:91], s[42:43] offset:1024 sc1
    global_store_dwordx4 v84, v[88:91], s[42:43] sc1
    s_lshl1_add_u32 s6, s70, s3
    s_lshl_b32 s6, s6, 2
    s_mov_b32 s73, 1
    s_waitcnt vmcnt(0)
    s_atomic_or s73, s[40:41], s6
    s_branch L_P1_b2

L_BW:
    s_mov_b32 s4, s70
    s_mov_b32 s5, s71
    v_mov_b32 v1, 0x24000
    v_lshl_add_u32 v5, v0, 2, v1
    v_mov_b32 v4, 0
    ds_write_b32 v5, v4
    s_mov_b32 s52, 0
    s_sub_u32 s53, s5, s4
    s_and_b32 s53, s53, 7
    s_lshl_b32 s53, s53, 2
    s_lshr_b32 s58, 0x54132100, s53
    s_lshr_b32 s53, 0x11411110, s53
    s_and_b32 s53, s53, 15
    s_sub_u32 s3, s3, 2
    v_lshrrev_b32 v12, 2, v3
    v_lshlrev_b32 v12, 8, v12
    v_lshl_add_u32 v12, v2, 6, v12
    v_and_b32 v13, 3, v0
    v_lshl_add_u32 v12, v13, 4, v12
    v_lshlrev_b32 v13, 4, v0
    s_and_b32 s58, s58, 7
    s_lshl2_add_u32 s58, s58, s3
    s_and_b32 s6, s53, 3
    s_cselect_b32 s6, 0, 336
    s_cselect_b32 s84, 24, 8
    s_cselect_b32 s85, 0, 48
    s_add_u32 s58, s58, s6
    s_add_u32 s85, s85, 336
    s_mov_b32 s83, s58
    s_lshr_b32 s59, s4, 3
    s_mul_i32 s59, s59, 128
    s_add_u32 s6, s58, s59
    s_and_b32 s6, s6, 511
    s_lshl_b32 s55, s6, 12
    s_lshl_b32 s7, s4, 21
    s_mov_b32 s10, 0x200000
    s_mov_b32 s11, 0x20000
    s_mov_b32 s14, 0x200000
    s_mov_b32 s15, 0x20000
    s_waitcnt lgkmcnt(0)
    s_add_u32 s8, s30, s7
    s_addc_u32 s9, s31, 0
    s_add_u32 s12, s32, s7
    s_addc_u32 s13, s33, 0
    s_mul_i32 s6, s4, 0x5300
    s_add_u32 s44, s42, s6
    s_addc_u32 s45, s43, 0
    s_mov_b32 s46, 0x5200
    s_mov_b32 s47, 0x20000
    s_mov_b32 s48, s42
    s_mov_b32 s49, s43
    s_mov_b32 s50, 0x400000
    s_mov_b32 s51, 0x20000
    s_lshl_b32 s6, s4, 8
    s_add_u32 s6, s6, 0x380000
    s_add_u32 s68, s42, s6
    s_addc_u32 s69, s43, 0
    s_and_b32 s6, s53, 3
    s_cbranch_scc0 L_ATT
    s_add_u32 s58, s83, s59
    s_mov_b32 s64, s18
    s_mov_b32 s65, s19
    s_mov_b32 s66, 0x800000
    s_mov_b32 s67, 0x20000
    s_lshr_b32 s6, s83, 2
    s_cmp_ge_u32 s6, 3
    s_cselect_b32 s7, 3, 0
    s_cselect_b32 s54, 1, 0
    s_sub_u32 s6, s6, s7
    s_lshr_b32 s56, s2, 6
    s_lshl3_add_u32 s56, s56, s7
    s_add_u32 s56, s56, s5
    s_and_b32 s56, s56, 31
    s_lshl1_add_u32 s54, s56, s54
    s_add_u32 s6, s6, s54
    s_add_u32 s6, s6, s3
    s_add_u32 s6, s6, 1
    s_and_b32 s6, s6, 3
    s_lshl2_add_u32 s6, s3, s6
    s_lshl4_add_u32 s6, s54, s6
    s_lshl_b32 s56, s6, 13
    s_add_u32 s57, s56, 0x1000
    v_and_b32 v10, 1, v3
    v_lshlrev_b32 v10, 4, v10
    v_mov_b32 v11, 0xffff
    v_lshlrev_b32 v10, v10, v11
    v_bfe_u32 v11, v3, 1, 2
    v_cmp_eq_u32 vcc, 0, v11
    s_nop 1
    v_cndmask_b32 v4, 0, v10, vcc
    v_cmp_eq_u32 vcc, 1, v11
    s_nop 1
    v_cndmask_b32 v5, 0, v10, vcc
    v_cmp_eq_u32 vcc, 2, v11
    s_nop 1
    v_cndmask_b32 v6, 0, v10, vcc
    v_cmp_eq_u32 vcc, 3, v11
    s_nop 1
    v_cndmask_b32 v7, 0, v10, vcc
    s_lshr_b32 s59, s4, 3
    s_mul_i32 s59, s59, 128
    s_lshl_b32 s6, s3, 9
    v_and_b32 v14, 7, v0
    v_lshl_add_u32 v14, v2, 3, v14
    v_lshl_add_u32 v14, v14, 4, v1
    v_add_u32 v14, s6, v14
    s_lshl_b32 s6, s3, 3
    v_add_u32 v15, s6, v1
    s_mov_b32 s72, s36
    s_mov_b32 s73, s37
    s_mov_b32 s74, 0x400000
    s_mov_b32 s75, 0x20000
    s_mov_b32 s76, s26
    s_mov_b32 s77, s27
    s_mov_b32 s78, 0x400000
    s_mov_b32 s79, 0x20000
    s_bfe_u32 s6, s2, 0x20003
    s_lshl2_add_u32 s6, s5, s6
    s_lshr_b32 s7, s2, 5
    s_lshl_b32 s6, s6, 17
    s_lshl_b32 s7, s7, 7
    s_add_u32 s63, s6, s7
    s_lshl_b32 s6, s4, 17
    s_lshl_b32 s7, s5, 7
    s_add_u32 s80, s6, s7
    v_lshrrev_b32 v104, 3, v0
    v_lshlrev_b32 v104, 10, v104
    v_and_b32 v10, 7, v0
    v_lshl_add_u32 v104, v10, 4, v104
    v_lshl_add_u32 v96, v0, 3, v1
    s_mul_i32 s6, s5, 0x300
    s_add_u32 s6, s6, 0x2980
    v_lshlrev_b32 v97, 2, v0
    v_add_u32 v97, s6, v97
    v_mov_b32 v98, 0x40000000
    v_writelane_b32 v98, s6, 0
    v_xor_b32 v105, 32, v104
    v_xor_b32 v106, 64, v104
    v_xor_b32 v107, 96, v104
    v_mov_b32 v88, 0xff7fffff
    v_mov_b32 v89, 0
    v_mov_b32 v68, 0
    v_mov_b32 v69, 0
    v_mov_b32 v70, 0
    v_mov_b32 v71, 0
    s_mov_b32 s60, 0x3e0293ee
    s_barrier
    buffer_load_dwordx4 v[128:131], v13, s[64:67], s56 offen offset:0
    buffer_load_dwordx4 v[132:135], v13, s[64:67], s56 offen offset:1024
    buffer_load_dwordx4 v[136:139], v13, s[64:67], s56 offen offset:2048
    buffer_load_dwordx4 v[140:143], v13, s[64:67], s56 offen offset:3072
    buffer_load_dwordx4 v[144:147], v13, s[64:67], s57 offen offset:0
    buffer_load_dwordx4 v[148:151], v13, s[64:67], s57 offen offset:1024
    buffer_load_dwordx4 v[152:155], v13, s[64:67], s57 offen offset:2048
    buffer_load_dwordx4 v[156:159], v13, s[64:67], s57 offen offset:3072
    s_add_u32 s6, s58, 0
    s_and_b32 s6, s6, 511
    s_lshl_b32 s55, s6, 12
    s_waitcnt vmcnt(4)
    buffer_load_dwordx4 v[160:163], v12, s[8:11], s55 offen offset:0 nt
    buffer_load_dwordx4 v[164:167], v12, s[8:11], s55 offen offset:1024 nt
    buffer_load_dwordx4 v[168:171], v12, s[8:11], s55 offen offset:2048 nt
    buffer_load_dwordx4 v[172:175], v12, s[8:11], s55 offen offset:3072 nt
    s_add_u32 s6, s58, 24
    s_and_b32 s6, s6, 511
    s_lshl_b32 s55, s6, 12
    s_waitcnt vmcnt(4)
    buffer_load_dwordx4 v[176:179], v12, s[8:11], s55 offen offset:0 nt
    buffer_load_dwordx4 v[180:183], v12, s[8:11], s55 offen offset:1024 nt
    buffer_load_dwordx4 v[184:187], v12, s[8:11], s55 offen offset:2048 nt
    buffer_load_dwordx4 v[188:191], v12, s[8:11], s55 offen offset:3072 nt
    s_add_u32 s6, s58, 48
    s_and_b32 s6, s6, 511
    s_lshl_b32 s55, s6, 12
    s_waitcnt vmcnt(4)
    buffer_load_dwordx4 v[192:195], v12, s[8:11], s55 offen offset:0 nt
    buffer_load_dwordx4 v[196:199], v12, s[8:11], s55 offen offset:1024 nt
    buffer_load_dwordx4 v[200:203], v12, s[8:11], s55 offen offset:2048 nt
    buffer_load_dwordx4 v[204:207], v12, s[8:11], s55 offen offset:3072 nt
    s_add_u32 s6, s58, 72
    s_and_b32 s6, s6, 511
    s_lshl_b32 s55, s6, 12
    s_waitcnt vmcnt(4)
    buffer_load_dwordx4 v[208:211], v12, s[8:11], s55 offen offset:0 nt
    buffer_load_dwordx4 v[212:215], v12, s[8:11], s55 offen offset:1024 nt
    buffer_load_dwordx4 v[216:219], v12, s[8:11], s55 offen offset:2048 nt
    buffer_load_dwordx4 v[220:223], v12, s[8:11], s55 offen offset:3072 nt
    s_add_u32 s6, s58, 96
    s_and_b32 s6, s6, 511
    s_lshl_b32 s55, s6, 12
    s_waitcnt vmcnt(4)
    buffer_load_dwordx4 v[224:227], v12, s[8:11], s55 offen offset:0 nt
    buffer_load_dwordx4 v[228:231], v12, s[8:11], s55 offen offset:1024 nt
    buffer_load_dwordx4 v[232:235], v12, s[8:11], s55 offen offset:2048 nt
    buffer_load_dwordx4 v[236:239], v12, s[8:11], s55 offen offset:3072 nt
    s_add_u32 s6, s58, 120
    s_and_b32 s6, s6, 511
    s_lshl_b32 s55, s6, 12
    s_waitcnt vmcnt(4)
    buffer_load_dwordx4 v[240:243], v12, s[8:11], s55 offen offset:0 nt
    buffer_load_dwordx4 v[244:247], v12, s[8:11], s55 offen offset:1024 nt
    buffer_load_dwordx4 v[248:251], v12, s[8:11], s55 offen offset:2048 nt
    buffer_load_dwordx4 v[252:255], v12, s[8:11], s55 offen offset:3072 nt
    s_add_u32 s6, s58, 144
    s_and_b32 s6, s6, 511
    s_lshl_b32 s55, s6, 12
    s_waitcnt vmcnt(4)
    buffer_load_dwordx4 v[32:35], v12, s[8:11], s55 offen offset:0 nt
    buffer_load_dwordx4 v[36:39], v12, s[8:11], s55 offen offset:1024 nt
    buffer_load_dwordx4 v[40:43], v12, s[8:11], s55 offen offset:2048 nt
    buffer_load_dwordx4 v[44:47], v12, s[8:11], s55 offen offset:3072 nt
    s_add_u32 s6, s58, 168
    s_and_b32 s6, s6, 511
    s_lshl_b32 s55, s6, 12
    s_waitcnt vmcnt(4)
    buffer_load_dwordx4 v[48:51], v12, s[8:11], s55 offen offset:0 nt
    buffer_load_dwordx4 v[52:55], v12, s[8:11], s55 offen offset:1024 nt
    buffer_load_dwordx4 v[56:59], v12, s[8:11], s55 offen offset:2048 nt
    buffer_load_dwordx4 v[60:63], v12, s[8:11], s55 offen offset:3072 nt
    s_add_u32 s6, s58, 192
    s_and_b32 s6, s6, 511
    s_lshl_b32 s55, s6, 12
    s_waitcnt vmcnt(4)
    buffer_load_dwordx4 v[128:131], v12, s[8:11], s55 offen offset:0 nt
    buffer_load_dwordx4 v[132:135], v12, s[8:11], s55 offen offset:1024 nt
    buffer_load_dwordx4 v[136:139], v12, s[8:11], s55 offen offset:2048 nt
    buffer_load_dwordx4 v[140:143], v12, s[8:11], s55 offen offset:3072 nt
    s_add_u32 s6, s58, 216
    s_and_b32 s6, s6, 511
    s_lshl_b32 s55, s6, 12
    s_waitcnt vmcnt(4)
    buffer_load_dwordx4 v[144:147], v12, s[8:11], s55 offen offset:0 nt
    buffer_load_dwordx4 v[148:151], v12, s[8:11], s55 offen offset:1024 nt
    buffer_load_dwordx4 v[152:155], v12, s[8:11], s55 offen offset:2048 nt
    buffer_load_dwordx4 v[156:159], v12, s[8:11], s55 offen offset:3072 nt
L_lw_46:
    ds_read_b32 v11, v1 offset:0
    s_waitcnt lgkmcnt(0)
    v_readfirstlane_b32 s6, v11
    s_nop 0
    s_cmp_ge_u32 s6, 1
    s_cbranch_scc1 L_lwd_47
    s_sleep 1
    s_add_u32 s52, s52, 1
    s_cmp_lt_u32 s52, 400000
    s_cbranch_scc1 L_lw_46
L_lwd_47:
    v_and_b32 v11, 3, v0
    v_lshl_add_u32 v11, v2, 2, v11
    v_lshl_add_u32 v11, v11, 4, v1
    ds_read_b128 v[92:95], v11 offset:256
    v_lshrrev_b32 v11, 2, v3
    s_waitcnt lgkmcnt(0)
    v_cmp_eq_u32 vcc, 0, v11
    s_nop 1
    v_cndmask_b32 v16, 0, v92, vcc
    v_cndmask_b32 v17, 0, v93, vcc
    v_cndmask_b32 v18, 0, v94, vcc
    v_cndmask_b32 v19, 0, v95, vcc
    v_cmp_eq_u32 vcc, 1, v11
    s_nop 1
    v_cndmask_b32 v20, 0, v92, vcc
    v_cndmask_b32 v21, 0, v93, vcc
    v_cndmask_b32 v22, 0, v94, vcc
    v_cndmask_b32 v23, 0, v95, vcc
    v_cmp_eq_u32 vcc, 2, v11
    s_nop 1
    v_cndmask_b32 v24, 0, v92, vcc
    v_cndmask_b32 v25, 0, v93, vcc
    v_cndmask_b32 v26, 0, v94, vcc
    v_cndmask_b32 v27, 0, v95, vcc
    v_cmp_eq_u32 vcc, 3, v11
    s_nop 1
    v_cndmask_b32 v28, 0, v92, vcc
    v_cndmask_b32 v29, 0, v93, vcc
    v_cndmask_b32 v30, 0, v94, vcc
    v_cndmask_b32 v31, 0, v95, vcc
    v_mfma_f32_16x16x32_bf16 v[64:67], v[160:163], v[16:19], 0
    v_mfma_f32_16x16x32_bf16 v[64:67], v[164:167], v[20:23], v[64:67]
    v_mfma_f32_16x16x32_bf16 v[64:67], v[168:171], v[24:27], v[64:67]
    v_mfma_f32_16x16x32_bf16 v[64:67], v[172:175], v[28:31], v[64:67]
    s_nop 7
    v_mov_b32_dpp v90, v64 quad_perm:[0,0,0,0] row_mask:0xf bank_mask:0xf
    s_nop 1
    v_add_f32_dpp v90, v65, v90 quad_perm:[1,1,1,1] row_mask:0xf bank_mask:0xf
    s_nop 1
    v_add_f32_dpp v90, v66, v90 quad_perm:[2,2,2,2] row_mask:0xf bank_mask:0xf
    s_nop 1
    v_add_f32_dpp v90, v67, v90 quad_perm:[3,3,3,3] row_mask:0xf bank_mask:0xf
    v_mul_f32 v108, s60, v90
    v_max_f32 v88, v108, v88
    v_mfma_f32_16x16x32_bf16 v[64:67], v[176:179], v[16:19], 0
    v_mfma_f32_16x16x32_bf16 v[64:67], v[180:183], v[20:23], v[64:67]
    v_mfma_f32_16x16x32_bf16 v[64:67], v[184:187], v[24:27], v[64:67]
    v_mfma_f32_16x16x32_bf16 v[64:67], v[188:191], v[28:31], v[64:67]
    s_nop 7
    v_mov_b32_dpp v90, v64 quad_perm:[0,0,0,0] row_mask:0xf bank_mask:0xf
    s_nop 1
    v_add_f32_dpp v90, v65, v90 quad_perm:[1,1,1,1] row_mask:0xf bank_mask:0xf
    s_nop 1
    v_add_f32_dpp v90, v66, v90 quad_perm:[2,2,2,2] row_mask:0xf bank_mask:0xf
    s_nop 1
    v_add_f32_dpp v90, v67, v90 quad_perm:[3,3,3,3] row_mask:0xf bank_mask:0xf
    v_mul_f32 v109, s60, v90
    v_max_f32 v88, v109, v88
    v_mfma_f32_16x16x32_bf16 v[64:67], v[192:195], v[16:19], 0
    v_mfma_f32_16x16x32_bf16 v[64:67], v[196:199], v[20:23], v[64:67]
    v_mfma_f32_16x16x32_bf16 v[64:67], v[200:203], v[24:27], v[64:67]
    v_mfma_f32_16x16x32_bf16 v[64:67], v[204:207], v[28:31], v[64:67]
    s_nop 7
    v_mov_b32_dpp v90, v64 quad_perm:[0,0,0,0] row_mask:0xf bank_mask:0xf
    s_nop 1
    v_add_f32_dpp v90, v65, v90 quad_perm:[1,1,1,1] row_mask:0xf bank_mask:0xf
    s_nop 1
    v_add_f32_dpp v90, v66, v90 quad_perm:[2,2,2,2] row_mask:0xf bank_mask:0xf
    s_nop 1
    v_add_f32_dpp v90, v67, v90 quad_perm:[3,3,3,3] row_mask:0xf bank_mask:0xf
    v_mul_f32 v110, s60, v90
    v_max_f32 v88, v110, v88
    v_mfma_f32_16x16x32_bf16 v[64:67], v[208:211], v[16:19], 0
    v_mfma_f32_16x16x32_bf16 v[64:67], v[212:215], v[20:23], v[64:67]
    v_mfma_f32_16x16x32_bf16 v[64:67], v[216:219], v[24:27], v[64:67]
    v_mfma_f32_16x16x32_bf16 v[64:67], v[220:223], v[28:31], v[64:67]
    s_nop 7
    v_mov_b32_dpp v90, v64 quad_perm:[0,0,0,0] row_mask:0xf bank_mask:0xf
    s_nop 1
    v_add_f32_dpp v90, v65, v90 quad_perm:[1,1,1,1] row_mask:0xf bank_mask:0xf
    s_nop 1
    v_add_f32_dpp v90, v66, v90 quad_perm:[2,2,2,2] row_mask:0xf bank_mask:0xf
    s_nop 1
    v_add_f32_dpp v90, v67, v90 quad_perm:[3,3,3,3] row_mask:0xf bank_mask:0xf
    v_mul_f32 v111, s60, v90
    v_max_f32 v88, v111, v88
    s_add_u32 s6, s58, 240
    s_and_b32 s6, s6, 511
    s_lshl_b32 s55, s6, 12
    s_waitcnt vmcnt(4)
    buffer_load_dwordx4 v[160:163], v12, s[8:11], s55 offen offset:0 nt
    buffer_load_dwordx4 v[164:167], v12, s[8:11], s55 offen offset:1024 nt
    buffer_load_dwordx4 v[168:171], v12, s[8:11], s55 offen offset:2048 nt
    buffer_load_dwordx4 v[172:175], v12, s[8:11], s55 offen offset:3072 nt
    v_mfma_f32_16x16x32_bf16 v[64:67], v[224:227], v[16:19], 0
    v_mfma_f32_16x16x32_bf16 v[64:67], v[228:231], v[20:23], v[64:67]
    v_mfma_f32_16x16x32_bf16 v[64:67], v[232:235], v[24:27], v[64:67]
    v_mfma_f32_16x16x32_bf16 v[64:67], v[236:239], v[28:31], v[64:67]
    s_nop 7
    v_mov_b32_dpp v90, v64 quad_perm:[0,0,0,0] row_mask:0xf bank_mask:0xf
    s_nop 1
    v_add_f32_dpp v90, v65, v90 quad_perm:[1,1,1,1] row_mask:0xf bank_mask:0xf
    s_nop 1
    v_add_f32_dpp v90, v66, v90 quad_perm:[2,2,2,2] row_mask:0xf bank_mask:0xf
    s_nop 1
    v_add_f32_dpp v90, v67, v90 quad_perm:[3,3,3,3] row_mask:0xf bank_mask:0xf
    v_mul_f32 v112, s60, v90
    v_max_f32 v88, v112, v88
    v_mfma_f32_16x16x32_bf16 v[64:67], v[240:243], v[16:19], 0
    v_mfma_f32_16x16x32_bf16 v[64:67], v[244:247], v[20:23], v[64:67]
    v_mfma_f32_16x16x32_bf16 v[64:67], v[248:251], v[24:27], v[64:67]
    v_mfma_f32_16x16x32_bf16 v[64:67], v[252:255], v[28:31], v[64:67]
    s_nop 7
    v_mov_b32_dpp v90, v64 quad_perm:[0,0,0,0] row_mask:0xf bank_mask:0xf
    s_nop 1
    v_add_f32_dpp v90, v65, v90 quad_perm:[1,1,1,1] row_mask:0xf bank_mask:0xf
    s_nop 1
    v_add_f32_dpp v90, v66, v90 quad_perm:[2,2,2,2] row_mask:0xf bank_mask:0xf
    s_nop 1
    v_add_f32_dpp v90, v67, v90 quad_perm:[3,3,3,3] row_mask:0xf bank_mask:0xf
    v_mul_f32 v113, s60, v90
    v_max_f32 v88, v113, v88
    v_mfma_f32_16x16x32_bf16 v[64:67], v[32:35], v[16:19], 0
    v_mfma_f32_16x16x32_bf16 v[64:67], v[36:39], v[20:23], v[64:67]
    v_mfma_f32_16x16x32_bf16 v[64:67], v[40:43], v[24:27], v[64:67]
    v_mfma_f32_16x16x32_bf16 v[64:67], v[44:47], v[28:31], v[64:67]
    s_nop 7
    v_mov_b32_dpp v90, v64 quad_perm:[0,0,0,0] row_mask:0xf bank_mask:0xf
    s_nop 1
    v_add_f32_dpp v90, v65, v90 quad_perm:[1,1,1,1] row_mask:0xf bank_mask:0xf
    s_nop 1
    v_add_f32_dpp v90, v66, v90 quad_perm:[2,2,2,2] row_mask:0xf bank_mask:0xf
    s_nop 1
    v_add_f32_dpp v90, v67, v90 quad_perm:[3,3,3,3] row_mask:0xf bank_mask:0xf
    v_mul_f32 v114, s60, v90
    v_max_f32 v88, v114, v88
    v_mfma_f32_16x16x32_bf16 v[64:67], v[48:51], v[16:19], 0
    v_mfma_f32_16x16x32_bf16 v[64:67], v[52:55], v[20:23], v[64:67]
    v_mfma_f32_16x16x32_bf16 v[64:67], v[56:59], v[24:27], v[64:67]
    v_mfma_f32_16x16x32_bf16 v[64:67], v[60:63], v[28:31], v[64:67]
    s_nop 7
    v_mov_b32_dpp v90, v64 quad_perm:[0,0,0,0] row_mask:0xf bank_mask:0xf
    s_nop 1
    v_add_f32_dpp v90, v65, v90 quad_perm:[1,1,1,1] row_mask:0xf bank_mask:0xf
    s_nop 1
    v_add_f32_dpp v90, v66, v90 quad_perm:[2,2,2,2] row_mask:0xf bank_mask:0xf
    s_nop 1
    v_add_f32_dpp v90, v67, v90 quad_perm:[3,3,3,3] row_mask:0xf bank_mask:0xf
    v_mul_f32 v115, s60, v90
    v_max_f32 v88, v115, v88
    s_add_u32 s6, s58, 264
    s_and_b32 s6, s6, 511
    s_lshl_b32 s55, s6, 12
    s_waitcnt vmcnt(4)
    buffer_load_dwordx4 v[176:179], v12, s[8:11], s55 offen offset:0 nt
    buffer_load_dwordx4 v[180:183], v12, s[8:11], s55 offen offset:1024 nt
    buffer_load_dwordx4 v[184:187], v12, s[8:11], s55 offen offset:2048 nt
    buffer_load_dwordx4 v[188:191], v12, s[8:11], s55 offen offset:3072 nt
    v_mfma_f32_16x16x32_bf16 v[64:67], v[128:131], v[16:19], 0
    v_mfma_f32_16x16x32_bf16 v[64:67], v[132:135], v[20:23], v[64:67]
    v_mfma_f32_16x16x32_bf16 v[64:67], v[136:139], v[24:27], v[64:67]
    v_mfma_f32_16x16x32_bf16 v[64:67], v[140:143], v[28:31], v[64:67]
    s_nop 7
    v_mov_b32_dpp v90, v64 quad_perm:[0,0,0,0] row_mask:0xf bank_mask:0xf
    s_nop 1
    v_add_f32_dpp v90, v65, v90 quad_perm:[1,1,1,1] row_mask:0xf bank_mask:0xf
    s_nop 1
    v_add_f32_dpp v90, v66, v90 quad_perm:[2,2,2,2] row_mask:0xf bank_mask:0xf
    s_nop 1
    v_add_f32_dpp v90, v67, v90 quad_perm:[3,3,3,3] row_mask:0xf bank_mask:0xf
    v_mul_f32 v116, s60, v90
    v_max_f32 v88, v116, v88
    v_mfma_f32_16x16x32_bf16 v[64:67], v[144:147], v[16:19], 0
    v_mfma_f32_16x16x32_bf16 v[64:67], v[148:151], v[20:23], v[64:67]
    v_mfma_f32_16x16x32_bf16 v[64:67], v[152:155], v[24:27], v[64:67]
    v_mfma_f32_16x16x32_bf16 v[64:67], v[156:159], v[28:31], v[64:67]
    s_nop 7
    v_mov_b32_dpp v90, v64 quad_perm:[0,0,0,0] row_mask:0xf bank_mask:0xf
    s_nop 1
    v_add_f32_dpp v90, v65, v90 quad_perm:[1,1,1,1] row_mask:0xf bank_mask:0xf
    s_nop 1
    v_add_f32_dpp v90, v66, v90 quad_perm:[2,2,2,2] row_mask:0xf bank_mask:0xf
    s_nop 1
    v_add_f32_dpp v90, v67, v90 quad_perm:[3,3,3,3] row_mask:0xf bank_mask:0xf
    v_mul_f32 v117, s60, v90
    v_max_f32 v88, v117, v88
    s_add_u32 s6, s58, 288
    s_and_b32 s6, s6, 511
    s_lshl_b32 s55, s6, 12
    s_waitcnt vmcnt(4)
    buffer_load_dwordx4 v[192:195], v12, s[8:11], s55 offen offset:0 nt
    buffer_load_dwordx4 v[196:199], v12, s[8:11], s55 offen offset:1024 nt
    buffer_load_dwordx4 v[200:203], v12, s[8:11], s55 offen offset:2048 nt
    buffer_load_dwordx4 v[204:207], v12, s[8:11], s55 offen offset:3072 nt
    v_mfma_f32_16x16x32_bf16 v[64:67], v[160:163], v[16:19], 0
    v_mfma_f32_16x16x32_bf16 v[64:67], v[164:167], v[20:23], v[64:67]
    v_mfma_f32_16x16x32_bf16 v[64:67], v[168:171], v[24:27], v[64:67]
    v_mfma_f32_16x16x32_bf16 v[64:67], v[172:175], v[28:31], v[64:67]
    s_nop 7
    v_mov_b32_dpp v90, v64 quad_perm:[0,0,0,0] row_mask:0xf bank_mask:0xf
    s_nop 1
    v_add_f32_dpp v90, v65, v90 quad_perm:[1,1,1,1] row_mask:0xf bank_mask:0xf
    s_nop 1
    v_add_f32_dpp v90, v66, v90 quad_perm:[2,2,2,2] row_mask:0xf bank_mask:0xf
    s_nop 1
    v_add_f32_dpp v90, v67, v90 quad_perm:[3,3,3,3] row_mask:0xf bank_mask:0xf
    v_mul_f32 v118, s60, v90
    v_max_f32 v88, v118, v88
    s_add_u32 s6, s58, 0
    s_and_b32 s6, s6, 511
    s_lshl_b32 s55, s6, 12
    s_waitcnt vmcnt(4)
    buffer_load_dwordx4 v[208:211], v13, s[12:15], s55 offen offset:0 nt
    buffer_load_dwordx4 v[212:215], v13, s[12:15], s55 offen offset:1024 nt
    buffer_load_dwordx4 v[216:219], v13, s[12:15], s55 offen offset:2048 nt
    buffer_load_dwordx4 v[220:223], v13, s[12:15], s55 offen offset:3072 nt
    v_mfma_f32_16x16x32_bf16 v[64:67], v[176:179], v[16:19], 0
    v_mfma_f32_16x16x32_bf16 v[64:67], v[180:183], v[20:23], v[64:67]
    v_mfma_f32_16x16x32_bf16 v[64:67], v[184:187], v[24:27], v[64:67]
    v_mfma_f32_16x16x32_bf16 v[64:67], v[188:191], v[28:31], v[64:67]
    s_nop 7
    v_mov_b32_dpp v90, v64 quad_perm:[0,0,0,0] row_mask:0xf bank_mask:0xf
    s_nop 1
    v_add_f32_dpp v90, v65, v90 quad_perm:[1,1,1,1] row_mask:0xf bank_mask:0xf
    s_nop 1
    v_add_f32_dpp v90, v66, v90 quad_perm:[2,2,2,2] row_mask:0xf bank_mask:0xf
    s_nop 1
    v_add_f32_dpp v90, v67, v90 quad_perm:[3,3,3,3] row_mask:0xf bank_mask:0xf
    v_mul_f32 v119, s60, v90
    v_max_f32 v88, v119, v88
    s_add_u32 s6, s58, 24
    s_and_b32 s6, s6, 511
    s_lshl_b32 s55, s6, 12
    s_waitcnt vmcnt(4)
    buffer_load_dwordx4 v[224:227], v13, s[12:15], s55 offen offset:0 nt
    buffer_load_dwordx4 v[228:231], v13, s[12:15], s55 offen offset:1024 nt
    buffer_load_dwordx4 v[232:235], v13, s[12:15], s55 offen offset:2048 nt
    buffer_load_dwordx4 v[236:239], v13, s[12:15], s55 offen offset:3072 nt
    v_mfma_f32_16x16x32_bf16 v[64:67], v[192:195], v[16:19], 0
    v_mfma_f32_16x16x32_bf16 v[64:67], v[196:199], v[20:23], v[64:67]
    v_mfma_f32_16x16x32_bf16 v[64:67], v[200:203], v[24:27], v[64:67]
    v_mfma_f32_16x16x32_bf16 v[64:67], v[204:207], v[28:31], v[64:67]
    s_nop 7
    v_mov_b32_dpp v90, v64 quad_perm:[0,0,0,0] row_mask:0xf bank_mask:0xf
    s_nop 1
    v_add_f32_dpp v90, v65, v90 quad_perm:[1,1,1,1] row_mask:0xf bank_mask:0xf
    s_nop 1
    v_add_f32_dpp v90, v66, v90 quad_perm:[2,2,2,2] row_mask:0xf bank_mask:0xf
    s_nop 1
    v_add_f32_dpp v90, v67, v90 quad_perm:[3,3,3,3] row_mask:0xf bank_mask:0xf
    v_mul_f32 v120, s60, v90
    v_max_f32 v88, v120, v88
    s_nop 1
    v_max_f32_dpp v88, v88, v88 row_ror:4 row_mask:0xf bank_mask:0xf
    s_nop 1
    v_max_f32_dpp v88, v88, v88 row_ror:8 row_mask:0xf bank_mask:0xf
    v_mov_b32 v92, v88
    s_nop 1
    v_permlane16_swap_b32 v88, v92
    v_max_f32 v88, v88, v92
    v_mov_b32 v92, v88
    s_nop 1
    v_permlane32_swap_b32 v88, v92
    v_max_f32 v88, v88, v92
    v_sub_f32 v90, v108, v88
    v_exp_f32 v90, v90
    s_nop 0
    v_add_f32 v89, v89, v90
    v_cvt_pk_bf16_f32 v90, v90, v90
    s_nop 1
    v_and_b32_dpp v72, v90, v4 row_newbcast:0 row_mask:0xf bank_mask:0xf
    v_and_b32_dpp v73, v90, v5 row_newbcast:0 row_mask:0xf bank_mask:0xf
    v_and_b32_dpp v74, v90, v6 row_newbcast:0 row_mask:0xf bank_mask:0xf
    v_and_b32_dpp v75, v90, v7 row_newbcast:0 row_mask:0xf bank_mask:0xf
    v_and_b32_dpp v76, v90, v4 row_newbcast:4 row_mask:0xf bank_mask:0xf
    v_and_b32_dpp v77, v90, v5 row_newbcast:4 row_mask:0xf bank_mask:0xf
    v_and_b32_dpp v78, v90, v6 row_newbcast:4 row_mask:0xf bank_mask:0xf
    v_and_b32_dpp v79, v90, v7 row_newbcast:4 row_mask:0xf bank_mask:0xf
    v_and_b32_dpp v80, v90, v4 row_newbcast:8 row_mask:0xf bank_mask:0xf
    v_and_b32_dpp v81, v90, v5 row_newbcast:8 row_mask:0xf bank_mask:0xf
    v_and_b32_dpp v82, v90, v6 row_newbcast:8 row_mask:0xf bank_mask:0xf
    v_and_b32_dpp v83, v90, v7 row_newbcast:8 row_mask:0xf bank_mask:0xf
    v_and_b32_dpp v84, v90, v4 row_newbcast:12 row_mask:0xf bank_mask:0xf
    v_and_b32_dpp v85, v90, v5 row_newbcast:12 row_mask:0xf bank_mask:0xf
    v_and_b32_dpp v86, v90, v6 row_newbcast:12 row_mask:0xf bank_mask:0xf
    v_and_b32_dpp v87, v90, v7 row_newbcast:12 row_mask:0xf bank_mask:0xf
    s_add_u32 s6, s58, 48
    s_and_b32 s6, s6, 511
    s_lshl_b32 s55, s6, 12
    s_waitcnt vmcnt(4)
    buffer_load_dwordx4 v[240:243], v13, s[12:15], s55 offen offset:0 nt
    buffer_load_dwordx4 v[244:247], v13, s[12:15], s55 offen offset:1024 nt
    buffer_load_dwordx4 v[248:251], v13, s[12:15], s55 offen offset:2048 nt
    buffer_load_dwordx4 v[252:255], v13, s[12:15], s55 offen offset:3072 nt
    v_mfma_f32_16x16x32_bf16 v[68:71], v[208:211], v[72:75], v[68:71]
    v_mfma_f32_16x16x32_bf16 v[68:71], v[212:215], v[76:79], v[68:71]
    v_mfma_f32_16x16x32_bf16 v[68:71], v[216:219], v[80:83], v[68:71]
    v_mfma_f32_16x16x32_bf16 v[68:71], v[220:223], v[84:87], v[68:71]
    v_sub_f32 v90, v109, v88
    v_exp_f32 v90, v90
    s_nop 0
    v_add_f32 v89, v89, v90
    v_cvt_pk_bf16_f32 v90, v90, v90
    s_nop 1
    v_and_b32_dpp v72, v90, v4 row_newbcast:0 row_mask:0xf bank_mask:0xf
    v_and_b32_dpp v73, v90, v5 row_newbcast:0 row_mask:0xf bank_mask:0xf
    v_and_b32_dpp v74, v90, v6 row_newbcast:0 row_mask:0xf bank_mask:0xf
    v_and_b32_dpp v75, v90, v7 row_newbcast:0 row_mask:0xf bank_mask:0xf
    v_and_b32_dpp v76, v90, v4 row_newbcast:4 row_mask:0xf bank_mask:0xf
    v_and_b32_dpp v77, v90, v5 row_newbcast:4 row_mask:0xf bank_mask:0xf
    v_and_b32_dpp v78, v90, v6 row_newbcast:4 row_mask:0xf bank_mask:0xf
    v_and_b32_dpp v79, v90, v7 row_newbcast:4 row_mask:0xf bank_mask:0xf
    v_and_b32_dpp v80, v90, v4 row_newbcast:8 row_mask:0xf bank_mask:0xf
    v_and_b32_dpp v81, v90, v5 row_newbcast:8 row_mask:0xf bank_mask:0xf
    v_and_b32_dpp v82, v90, v6 row_newbcast:8 row_mask:0xf bank_mask:0xf
    v_and_b32_dpp v83, v90, v7 row_newbcast:8 row_mask:0xf bank_mask:0xf
    v_and_b32_dpp v84, v90, v4 row_newbcast:12 row_mask:0xf bank_mask:0xf
    v_and_b32_dpp v85, v90, v5 row_newbcast:12 row_mask:0xf bank_mask:0xf
    v_and_b32_dpp v86, v90, v6 row_newbcast:12 row_mask:0xf bank_mask:0xf
    v_and_b32_dpp v87, v90, v7 row_newbcast:12 row_mask:0xf bank_mask:0xf
    s_add_u32 s6, s58, 72
    s_and_b32 s6, s6, 511
    s_lshl_b32 s55, s6, 12
    s_waitcnt vmcnt(4)
    buffer_load_dwordx4 v[32:35], v13, s[12:15], s55 offen offset:0 nt
    buffer_load_dwordx4 v[36:39], v13, s[12:15], s55 offen offset:1024 nt
    buffer_load_dwordx4 v[40:43], v13, s[12:15], s55 offen offset:2048 nt
    buffer_load_dwordx4 v[44:47], v13, s[12:15], s55 offen offset:3072 nt
    v_mfma_f32_16x16x32_bf16 v[68:71], v[224:227], v[72:75], v[68:71]
    v_mfma_f32_16x16x32_bf16 v[68:71], v[228:231], v[76:79], v[68:71]
    v_mfma_f32_16x16x32_bf16 v[68:71], v[232:235], v[80:83], v[68:71]
    v_mfma_f32_16x16x32_bf16 v[68:71], v[236:239], v[84:87], v[68:71]
    v_sub_f32 v90, v110, v88
    v_exp_f32 v90, v90
    s_nop 0
    v_add_f32 v89, v89, v90
    v_cvt_pk_bf16_f32 v90, v90, v90
    s_nop 1
    v_and_b32_dpp v72, v90, v4 row_newbcast:0 row_mask:0xf bank_mask:0xf
    v_and_b32_dpp v73, v90, v5 row_newbcast:0 row_mask:0xf bank_mask:0xf
    v_and_b32_dpp v74, v90, v6 row_newbcast:0 row_mask:0xf bank_mask:0xf
    v_and_b32_dpp v75, v90, v7 row_newbcast:0 row_mask:0xf bank_mask:0xf
    v_and_b32_dpp v76, v90, v4 row_newbcast:4 row_mask:0xf bank_mask:0xf
    v_and_b32_dpp v77, v90, v5 row_newbcast:4 row_mask:0xf bank_mask:0xf
    v_and_b32_dpp v78, v90, v6 row_newbcast:4 row_mask:0xf bank_mask:0xf
    v_and_b32_dpp v79, v90, v7 row_newbcast:4 row_mask:0xf bank_mask:0xf
    v_and_b32_dpp v80, v90, v4 row_newbcast:8 row_mask:0xf bank_mask:0xf
    v_and_b32_dpp v81, v90, v5 row_newbcast:8 row_mask:0xf bank_mask:0xf
    v_and_b32_dpp v82, v90, v6 row_newbcast:8 row_mask:0xf bank_mask:0xf
    v_and_b32_dpp v83, v90, v7 row_newbcast:8 row_mask:0xf bank_mask:0xf
    v_and_b32_dpp v84, v90, v4 row_newbcast:12 row_mask:0xf bank_mask:0xf
    v_and_b32_dpp v85, v90, v5 row_newbcast:12 row_mask:0xf bank_mask:0xf
    v_and_b32_dpp v86, v90, v6 row_newbcast:12 row_mask:0xf bank_mask:0xf
    v_and_b32_dpp v87, v90, v7 row_newbcast:12 row_mask:0xf bank_mask:0xf
    s_add_u32 s6, s58, 96
    s_and_b32 s6, s6, 511
    s_lshl_b32 s55, s6, 12
    s_waitcnt vmcnt(4)
    buffer_load_dwordx4 v[48:51], v13, s[12:15], s55 offen offset:0 nt
    buffer_load_dwordx4 v[52:55], v13, s[12:15], s55 offen offset:1024 nt
    buffer_load_dwordx4 v[56:59], v13, s[12:15], s55 offen offset:2048 nt
    buffer_load_dwordx4 v[60:63], v13, s[12:15], s55 offen offset:3072 nt
    v_mfma_f32_16x16x32_bf16 v[68:71], v[240:243], v[72:75], v[68:71]
    v_mfma_f32_16x16x32_bf16 v[68:71], v[244:247], v[76:79], v[68:71]
    v_mfma_f32_16x16x32_bf16 v[68:71], v[248:251], v[80:83], v[68:71]
    v_mfma_f32_16x16x32_bf16 v[68:71], v[252:255], v[84:87], v[68:71]
    v_sub_f32 v90, v111, v88
    v_exp_f32 v90, v90
    s_nop 0
    v_add_f32 v89, v89, v90
    v_cvt_pk_bf16_f32 v90, v90, v90
    s_nop 1
    v_and_b32_dpp v72, v90, v4 row_newbcast:0 row_mask:0xf bank_mask:0xf
    v_and_b32_dpp v73, v90, v5 row_newbcast:0 row_mask:0xf bank_mask:0xf
    v_and_b32_dpp v74, v90, v6 row_newbcast:0 row_mask:0xf bank_mask:0xf
    v_and_b32_dpp v75, v90, v7 row_newbcast:0 row_mask:0xf bank_mask:0xf
    v_and_b32_dpp v76, v90, v4 row_newbcast:4 row_mask:0xf bank_mask:0xf
    v_and_b32_dpp v77, v90, v5 row_newbcast:4 row_mask:0xf bank_mask:0xf
    v_and_b32_dpp v78, v90, v6 row_newbcast:4 row_mask:0xf bank_mask:0xf
    v_and_b32_dpp v79, v90, v7 row_newbcast:4 row_mask:0xf bank_mask:0xf
    v_and_b32_dpp v80, v90, v4 row_newbcast:8 row_mask:0xf bank_mask:0xf
    v_and_b32_dpp v81, v90, v5 row_newbcast:8 row_mask:0xf bank_mask:0xf
    v_and_b32_dpp v82, v90, v6 row_newbcast:8 row_mask:0xf bank_mask:0xf
    v_and_b32_dpp v83, v90, v7 row_newbcast:8 row_mask:0xf bank_mask:0xf
    v_and_b32_dpp v84, v90, v4 row_newbcast:12 row_mask:0xf bank_mask:0xf
    v_and_b32_dpp v85, v90, v5 row_newbcast:12 row_mask:0xf bank_mask:0xf
    v_and_b32_dpp v86, v90, v6 row_newbcast:12 row_mask:0xf bank_mask:0xf
    v_and_b32_dpp v87, v90, v7 row_newbcast:12 row_mask:0xf bank_mask:0xf
    s_add_u32 s6, s58, 120
    s_and_b32 s6, s6, 511
    s_lshl_b32 s55, s6, 12
    s_waitcnt vmcnt(4)
    buffer_load_dwordx4 v[128:131], v13, s[12:15], s55 offen offset:0 nt
    buffer_load_dwordx4 v[132:135], v13, s[12:15], s55 offen offset:1024 nt
    buffer_load_dwordx4 v[136:139], v13, s[12:15], s55 offen offset:2048 nt
    buffer_load_dwordx4 v[140:143], v13, s[12:15], s55 offen offset:3072 nt
    v_mfma_f32_16x16x32_bf16 v[68:71], v[32:35], v[72:75], v[68:71]
    v_mfma_f32_16x16x32_bf16 v[68:71], v[36:39], v[76:79], v[68:71]
    v_mfma_f32_16x16x32_bf16 v[68:71], v[40:43], v[80:83], v[68:71]
    v_mfma_f32_16x16x32_bf16 v[68:71], v[44:47], v[84:87], v[68:71]
    v_sub_f32 v90, v112, v88
    v_exp_f32 v90, v90
    s_nop 0
    v_add_f32 v89, v89, v90
    v_cvt_pk_bf16_f32 v90, v90, v90
    s_nop 1
    v_and_b32_dpp v72, v90, v4 row_newbcast:0 row_mask:0xf bank_mask:0xf
    v_and_b32_dpp v73, v90, v5 row_newbcast:0 row_mask:0xf bank_mask:0xf
    v_and_b32_dpp v74, v90, v6 row_newbcast:0 row_mask:0xf bank_mask:0xf
    v_and_b32_dpp v75, v90, v7 row_newbcast:0 row_mask:0xf bank_mask:0xf
    v_and_b32_dpp v76, v90, v4 row_newbcast:4 row_mask:0xf bank_mask:0xf
    v_and_b32_dpp v77, v90, v5 row_newbcast:4 row_mask:0xf bank_mask:0xf
    v_and_b32_dpp v78, v90, v6 row_newbcast:4 row_mask:0xf bank_mask:0xf
    v_and_b32_dpp v79, v90, v7 row_newbcast:4 row_mask:0xf bank_mask:0xf
    v_and_b32_dpp v80, v90, v4 row_newbcast:8 row_mask:0xf bank_mask:0xf
    v_and_b32_dpp v81, v90, v5 row_newbcast:8 row_mask:0xf bank_mask:0xf
    v_and_b32_dpp v82, v90, v6 row_newbcast:8 row_mask:0xf bank_mask:0xf
    v_and_b32_dpp v83, v90, v7 row_newbcast:8 row_mask:0xf bank_mask:0xf
    v_and_b32_dpp v84, v90, v4 row_newbcast:12 row_mask:0xf bank_mask:0xf
    v_and_b32_dpp v85, v90, v5 row_newbcast:12 row_mask:0xf bank_mask:0xf
    v_and_b32_dpp v86, v90, v6 row_newbcast:12 row_mask:0xf bank_mask:0xf
    v_and_b32_dpp v87, v90, v7 row_newbcast:12 row_mask:0xf bank_mask:0xf
    s_add_u32 s6, s58, 144
    s_and_b32 s6, s6, 511
    s_lshl_b32 s55, s6, 12
    s_waitcnt vmcnt(4)
    buffer_load_dwordx4 v[144:147], v13, s[12:15], s55 offen offset:0 nt
    buffer_load_dwordx4 v[148:151], v13, s[12:15], s55 offen offset:1024 nt
    buffer_load_dwordx4 v[152:155], v13, s[12:15], s55 offen offset:2048 nt
    buffer_load_dwordx4 v[156:159], v13, s[12:15], s55 offen offset:3072 nt
    v_mfma_f32_16x16x32_bf16 v[68:71], v[48:51], v[72:75], v[68:71]
    v_mfma_f32_16x16x32_bf16 v[68:71], v[52:55], v[76:79], v[68:71]
    v_mfma_f32_16x16x32_bf16 v[68:71], v[56:59], v[80:83], v[68:71]
    v_mfma_f32_16x16x32_bf16 v[68:71], v[60:63], v[84:87], v[68:71]
    v_sub_f32 v90, v113, v88
    v_exp_f32 v90, v90
    s_nop 0
    v_add_f32 v89, v89, v90
    v_cvt_pk_bf16_f32 v90, v90, v90
    s_nop 1
    v_and_b32_dpp v72, v90, v4 row_newbcast:0 row_mask:0xf bank_mask:0xf
    v_and_b32_dpp v73, v90, v5 row_newbcast:0 row_mask:0xf bank_mask:0xf
    v_and_b32_dpp v74, v90, v6 row_newbcast:0 row_mask:0xf bank_mask:0xf
    v_and_b32_dpp v75, v90, v7 row_newbcast:0 row_mask:0xf bank_mask:0xf
    v_and_b32_dpp v76, v90, v4 row_newbcast:4 row_mask:0xf bank_mask:0xf
    v_and_b32_dpp v77, v90, v5 row_newbcast:4 row_mask:0xf bank_mask:0xf
    v_and_b32_dpp v78, v90, v6 row_newbcast:4 row_mask:0xf bank_mask:0xf
    v_and_b32_dpp v79, v90, v7 row_newbcast:4 row_mask:0xf bank_mask:0xf
    v_and_b32_dpp v80, v90, v4 row_newbcast:8 row_mask:0xf bank_mask:0xf
    v_and_b32_dpp v81, v90, v5 row_newbcast:8 row_mask:0xf bank_mask:0xf
    v_and_b32_dpp v82, v90, v6 row_newbcast:8 row_mask:0xf bank_mask:0xf
    v_and_b32_dpp v83, v90, v7 row_newbcast:8 row_mask:0xf bank_mask:0xf
    v_and_b32_dpp v84, v90, v4 row_newbcast:12 row_mask:0xf bank_mask:0xf
    v_and_b32_dpp v85, v90, v5 row_newbcast:12 row_mask:0xf bank_mask:0xf
    v_and_b32_dpp v86, v90, v6 row_newbcast:12 row_mask:0xf bank_mask:0xf
    v_and_b32_dpp v87, v90, v7 row_newbcast:12 row_mask:0xf bank_mask:0xf
    s_add_u32 s6, s58, 168
    s_and_b32 s6, s6, 511
    s_lshl_b32 s55, s6, 12
    s_waitcnt vmcnt(4)
    buffer_load_dwordx4 v[160:163], v13, s[12:15], s55 offen offset:0 nt
    buffer_load_dwordx4 v[164:167], v13, s[12:15], s55 offen offset:1024 nt
    buffer_load_dwordx4 v[168:171], v13, s[12:15], s55 offen offset:2048 nt
    buffer_load_dwordx4 v[172:175], v13, s[12:15], s55 offen offset:3072 nt
    v_mfma_f32_16x16x32_bf16 v[68:71], v[128:131], v[72:75], v[68:71]
    v_mfma_f32_16x16x32_bf16 v[68:71], v[132:135], v[76:79], v[68:71]
    v_mfma_f32_16x16x32_bf16 v[68:71], v[136:139], v[80:83], v[68:71]
    v_mfma_f32_16x16x32_bf16 v[68:71], v[140:143], v[84:87], v[68:71]
    v_sub_f32 v90, v114, v88
    v_exp_f32 v90, v90
    s_nop 0
    v_add_f32 v89, v89, v90
    v_cvt_pk_bf16_f32 v90, v90, v90
    s_nop 1
    v_and_b32_dpp v72, v90, v4 row_newbcast:0 row_mask:0xf bank_mask:0xf
    v_and_b32_dpp v73, v90, v5 row_newbcast:0 row_mask:0xf bank_mask:0xf
    v_and_b32_dpp v74, v90, v6 row_newbcast:0 row_mask:0xf bank_mask:0xf
    v_and_b32_dpp v75, v90, v7 row_newbcast:0 row_mask:0xf bank_mask:0xf
    v_and_b32_dpp v76, v90, v4 row_newbcast:4 row_mask:0xf bank_mask:0xf
    v_and_b32_dpp v77, v90, v5 row_newbcast:4 row_mask:0xf bank_mask:0xf
    v_and_b32_dpp v78, v90, v6 row_newbcast:4 row_mask:0xf bank_mask:0xf
    v_and_b32_dpp v79, v90, v7 row_newbcast:4 row_mask:0xf bank_mask:0xf
    v_and_b32_dpp v80, v90, v4 row_newbcast:8 row_mask:0xf bank_mask:0xf
    v_and_b32_dpp v81, v90, v5 row_newbcast:8 row_mask:0xf bank_mask:0xf
    v_and_b32_dpp v82, v90, v6 row_newbcast:8 row_mask:0xf bank_mask:0xf
    v_and_b32_dpp v83, v90, v7 row_newbcast:8 row_mask:0xf bank_mask:0xf
    v_and_b32_dpp v84, v90, v4 row_newbcast:12 row_mask:0xf bank_mask:0xf
    v_and_b32_dpp v85, v90, v5 row_newbcast:12 row_mask:0xf bank_mask:0xf
    v_and_b32_dpp v86, v90, v6 row_newbcast:12 row_mask:0xf bank_mask:0xf
    v_and_b32_dpp v87, v90, v7 row_newbcast:12 row_mask:0xf bank_mask:0xf
    s_add_u32 s6, s58, 192
    s_and_b32 s6, s6, 511
    s_lshl_b32 s55, s6, 12
    s_waitcnt vmcnt(4)
    buffer_load_dwordx4 v[176:179], v13, s[12:15], s55 offen offset:0 nt
    buffer_load_dwordx4 v[180:183], v13, s[12:15], s55 offen offset:1024 nt
    buffer_load_dwordx4 v[184:187], v13, s[12:15], s55 offen offset:2048 nt
    buffer_load_dwordx4 v[188:191], v13, s[12:15], s55 offen offset:3072 nt
    v_mfma_f32_16x16x32_bf16 v[68:71], v[144:147], v[72:75], v[68:71]
    v_mfma_f32_16x16x32_bf16 v[68:71], v[148:151], v[76:79], v[68:71]
    v_mfma_f32_16x16x32_bf16 v[68:71], v[152:155], v[80:83], v[68:71]
    v_mfma_f32_16x16x32_bf16 v[68:71], v[156:159], v[84:87], v[68:71]
    v_sub_f32 v90, v115, v88
    v_exp_f32 v90, v90
    s_nop 0
    v_add_f32 v89, v89, v90
    v_cvt_pk_bf16_f32 v90, v90, v90
    s_nop 1
    v_and_b32_dpp v72, v90, v4 row_newbcast:0 row_mask:0xf bank_mask:0xf
    v_and_b32_dpp v73, v90, v5 row_newbcast:0 row_mask:0xf bank_mask:0xf
    v_and_b32_dpp v74, v90, v6 row_newbcast:0 row_mask:0xf bank_mask:0xf
    v_and_b32_dpp v75, v90, v7 row_newbcast:0 row_mask:0xf bank_mask:0xf
    v_and_b32_dpp v76, v90, v4 row_newbcast:4 row_mask:0xf bank_mask:0xf
    v_and_b32_dpp v77, v90, v5 row_newbcast:4 row_mask:0xf bank_mask:0xf
    v_and_b32_dpp v78, v90, v6 row_newbcast:4 row_mask:0xf bank_mask:0xf
    v_and_b32_dpp v79, v90, v7 row_newbcast:4 row_mask:0xf bank_mask:0xf
    v_and_b32_dpp v80, v90, v4 row_newbcast:8 row_mask:0xf bank_mask:0xf
    v_and_b32_dpp v81, v90, v5 row_newbcast:8 row_mask:0xf bank_mask:0xf
    v_and_b32_dpp v82, v90, v6 row_newbcast:8 row_mask:0xf bank_mask:0xf
    v_and_b32_dpp v83, v90, v7 row_newbcast:8 row_mask:0xf bank_mask:0xf
    v_and_b32_dpp v84, v90, v4 row_newbcast:12 row_mask:0xf bank_mask:0xf
    v_and_b32_dpp v85, v90, v5 row_newbcast:12 row_mask:0xf bank_mask:0xf
    v_and_b32_dpp v86, v90, v6 row_newbcast:12 row_mask:0xf bank_mask:0xf
    v_and_b32_dpp v87, v90, v7 row_newbcast:12 row_mask:0xf bank_mask:0xf
    s_add_u32 s6, s58, 216
    s_and_b32 s6, s6, 511
    s_lshl_b32 s55, s6, 12
    s_waitcnt vmcnt(4)
    buffer_load_dwordx4 v[192:195], v13, s[12:15], s55 offen offset:0 nt
    buffer_load_dwordx4 v[196:199], v13, s[12:15], s55 offen offset:1024 nt
    buffer_load_dwordx4 v[200:203], v13, s[12:15], s55 offen offset:2048 nt
    buffer_load_dwordx4 v[204:207], v13, s[12:15], s55 offen offset:3072 nt
    v_mfma_f32_16x16x32_bf16 v[68:71], v[160:163], v[72:75], v[68:71]
    v_mfma_f32_16x16x32_bf16 v[68:71], v[164:167], v[76:79], v[68:71]
    v_mfma_f32_16x16x32_bf16 v[68:71], v[168:171], v[80:83], v[68:71]
    v_mfma_f32_16x16x32_bf16 v[68:71], v[172:175], v[84:87], v[68:71]
    v_sub_f32 v90, v116, v88
    v_exp_f32 v90, v90
    s_nop 0
    v_add_f32 v89, v89, v90
    v_cvt_pk_bf16_f32 v90, v90, v90
    s_nop 1
    v_and_b32_dpp v72, v90, v4 row_newbcast:0 row_mask:0xf bank_mask:0xf
    v_and_b32_dpp v73, v90, v5 row_newbcast:0 row_mask:0xf bank_mask:0xf
    v_and_b32_dpp v74, v90, v6 row_newbcast:0 row_mask:0xf bank_mask:0xf
    v_and_b32_dpp v75, v90, v7 row_newbcast:0 row_mask:0xf bank_mask:0xf
    v_and_b32_dpp v76, v90, v4 row_newbcast:4 row_mask:0xf bank_mask:0xf
    v_and_b32_dpp v77, v90, v5 row_newbcast:4 row_mask:0xf bank_mask:0xf
    v_and_b32_dpp v78, v90, v6 row_newbcast:4 row_mask:0xf bank_mask:0xf
    v_and_b32_dpp v79, v90, v7 row_newbcast:4 row_mask:0xf bank_mask:0xf
    v_and_b32_dpp v80, v90, v4 row_newbcast:8 row_mask:0xf bank_mask:0xf
    v_and_b32_dpp v81, v90, v5 row_newbcast:8 row_mask:0xf bank_mask:0xf
    v_and_b32_dpp v82, v90, v6 row_newbcast:8 row_mask:0xf bank_mask:0xf
    v_and_b32_dpp v83, v90, v7 row_newbcast:8 row_mask:0xf bank_mask:0xf
    v_and_b32_dpp v84, v90, v4 row_newbcast:12 row_mask:0xf bank_mask:0xf
    v_and_b32_dpp v85, v90, v5 row_newbcast:12 row_mask:0xf bank_mask:0xf
    v_and_b32_dpp v86, v90, v6 row_newbcast:12 row_mask:0xf bank_mask:0xf
    v_and_b32_dpp v87, v90, v7 row_newbcast:12 row_mask:0xf bank_mask:0xf
    s_add_u32 s6, s58, 240
    s_and_b32 s6, s6, 511
    s_lshl_b32 s55, s6, 12
    s_waitcnt vmcnt(4)
    buffer_load_dwordx4 v[208:211], v13, s[12:15], s55 offen offset:0 nt
    buffer_load_dwordx4 v[212:215], v13, s[12:15], s55 offen offset:1024 nt
    buffer_load_dwordx4 v[216:219], v13, s[12:15], s55 offen offset:2048 nt
    buffer_load_dwordx4 v[220:223], v13, s[12:15], s55 offen offset:3072 nt
    v_mfma_f32_16x16x32_bf16 v[68:71], v[176:179], v[72:75], v[68:71]
    v_mfma_f32_16x16x32_bf16 v[68:71], v[180:183], v[76:79], v[68:71]
    v_mfma_f32_16x16x32_bf16 v[68:71], v[184:187], v[80:83], v[68:71]
    v_mfma_f32_16x16x32_bf16 v[68:71], v[188:191], v[84:87], v[68:71]
    v_sub_f32 v90, v117, v88
    v_exp_f32 v90, v90
    s_nop 0
    v_add_f32 v89, v89, v90
    v_cvt_pk_bf16_f32 v90, v90, v90
    s_nop 1
    v_and_b32_dpp v72, v90, v4 row_newbcast:0 row_mask:0xf bank_mask:0xf
    v_and_b32_dpp v73, v90, v5 row_newbcast:0 row_mask:0xf bank_mask:0xf
    v_and_b32_dpp v74, v90, v6 row_newbcast:0 row_mask:0xf bank_mask:0xf
    v_and_b32_dpp v75, v90, v7 row_newbcast:0 row_mask:0xf bank_mask:0xf
    v_and_b32_dpp v76, v90, v4 row_newbcast:4 row_mask:0xf bank_mask:0xf
    v_and_b32_dpp v77, v90, v5 row_newbcast:4 row_mask:0xf bank_mask:0xf
    v_and_b32_dpp v78, v90, v6 row_newbcast:4 row_mask:0xf bank_mask:0xf
    v_and_b32_dpp v79, v90, v7 row_newbcast:4 row_mask:0xf bank_mask:0xf
    v_and_b32_dpp v80, v90, v4 row_newbcast:8 row_mask:0xf bank_mask:0xf
    v_and_b32_dpp v81, v90, v5 row_newbcast:8 row_mask:0xf bank_mask:0xf
    v_and_b32_dpp v82, v90, v6 row_newbcast:8 row_mask:0xf bank_mask:0xf
    v_and_b32_dpp v83, v90, v7 row_newbcast:8 row_mask:0xf bank_mask:0xf
    v_and_b32_dpp v84, v90, v4 row_newbcast:12 row_mask:0xf bank_mask:0xf
    v_and_b32_dpp v85, v90, v5 row_newbcast:12 row_mask:0xf bank_mask:0xf
    v_and_b32_dpp v86, v90, v6 row_newbcast:12 row_mask:0xf bank_mask:0xf
    v_and_b32_dpp v87, v90, v7 row_newbcast:12 row_mask:0xf bank_mask:0xf
    s_add_u32 s6, s58, 264
    s_and_b32 s6, s6, 511
    s_lshl_b32 s55, s6, 12
    s_waitcnt vmcnt(4)
    buffer_load_dwordx4 v[224:227], v13, s[12:15], s55 offen offset:0 nt
    buffer_load_dwordx4 v[228:231], v13, s[12:15], s55 offen offset:1024 nt
    buffer_load_dwordx4 v[232:235], v13, s[12:15], s55 offen offset:2048 nt
    buffer_load_dwordx4 v[236:239], v13, s[12:15], s55 offen offset:3072 nt
    v_mfma_f32_16x16x32_bf16 v[68:71], v[192:195], v[72:75], v[68:71]
    v_mfma_f32_16x16x32_bf16 v[68:71], v[196:199], v[76:79], v[68:71]
    v_mfma_f32_16x16x32_bf16 v[68:71], v[200:203], v[80:83], v[68:71]
    v_mfma_f32_16x16x32_bf16 v[68:71], v[204:207], v[84:87], v[68:71]
    v_sub_f32 v90, v118, v88
    v_exp_f32 v90, v90
    s_nop 0
    v_add_f32 v89, v89, v90
    v_cvt_pk_bf16_f32 v90, v90, v90
    s_nop 1
    v_and_b32_dpp v72, v90, v4 row_newbcast:0 row_mask:0xf bank_mask:0xf
    v_and_b32_dpp v73, v90, v5 row_newbcast:0 row_mask:0xf bank_mask:0xf
    v_and_b32_dpp v74, v90, v6 row_newbcast:0 row_mask:0xf bank_mask:0xf
    v_and_b32_dpp v75, v90, v7 row_newbcast:0 row_mask:0xf bank_mask:0xf
    v_and_b32_dpp v76, v90, v4 row_newbcast:4 row_mask:0xf bank_mask:0xf
    v_and_b32_dpp v77, v90, v5 row_newbcast:4 row_mask:0xf bank_mask:0xf
    v_and_b32_dpp v78, v90, v6 row_newbcast:4 row_mask:0xf bank_mask:0xf
    v_and_b32_dpp v79, v90, v7 row_newbcast:4 row_mask:0xf bank_mask:0xf
    v_and_b32_dpp v80, v90, v4 row_newbcast:8 row_mask:0xf bank_mask:0xf
    v_and_b32_dpp v81, v90, v5 row_newbcast:8 row_mask:0xf bank_mask:0xf
    v_and_b32_dpp v82, v90, v6 row_newbcast:8 row_mask:0xf bank_mask:0xf
    v_and_b32_dpp v83, v90, v7 row_newbcast:8 row_mask:0xf bank_mask:0xf
    v_and_b32_dpp v84, v90, v4 row_newbcast:12 row_mask:0xf bank_mask:0xf
    v_and_b32_dpp v85, v90, v5 row_newbcast:12 row_mask:0xf bank_mask:0xf
    v_and_b32_dpp v86, v90, v6 row_newbcast:12 row_mask:0xf bank_mask:0xf
    v_and_b32_dpp v87, v90, v7 row_newbcast:12 row_mask:0xf bank_mask:0xf
    s_add_u32 s6, s58, 288
    s_and_b32 s6, s6, 511
    s_lshl_b32 s55, s6, 12
    s_waitcnt vmcnt(4)
    buffer_load_dwordx4 v[240:243], v13, s[12:15], s55 offen offset:0 nt
    buffer_load_dwordx4 v[244:247], v13, s[12:15], s55 offen offset:1024 nt
    buffer_load_dwordx4 v[248:251], v13, s[12:15], s55 offen offset:2048 nt
    buffer_load_dwordx4 v[252:255], v13, s[12:15], s55 offen offset:3072 nt
    v_mfma_f32_16x16x32_bf16 v[68:71], v[208:211], v[72:75], v[68:71]
    v_mfma_f32_16x16x32_bf16 v[68:71], v[212:215], v[76:79], v[68:71]
    v_mfma_f32_16x16x32_bf16 v[68:71], v[216:219], v[80:83], v[68:71]
    v_mfma_f32_16x16x32_bf16 v[68:71], v[220:223], v[84:87], v[68:71]
    v_sub_f32 v90, v119, v88
    v_exp_f32 v90, v90
    s_nop 0
    v_add_f32 v89, v89, v90
    v_cvt_pk_bf16_f32 v90, v90, v90
    s_nop 1
    v_and_b32_dpp v72, v90, v4 row_newbcast:0 row_mask:0xf bank_mask:0xf
    v_and_b32_dpp v73, v90, v5 row_newbcast:0 row_mask:0xf bank_mask:0xf
    v_and_b32_dpp v74, v90, v6 row_newbcast:0 row_mask:0xf bank_mask:0xf
    v_and_b32_dpp v75, v90, v7 row_newbcast:0 row_mask:0xf bank_mask:0xf
    v_and_b32_dpp v76, v90, v4 row_newbcast:4 row_mask:0xf bank_mask:0xf
    v_and_b32_dpp v77, v90, v5 row_newbcast:4 row_mask:0xf bank_mask:0xf
    v_and_b32_dpp v78, v90, v6 row_newbcast:4 row_mask:0xf bank_mask:0xf
    v_and_b32_dpp v79, v90, v7 row_newbcast:4 row_mask:0xf bank_mask:0xf
    v_and_b32_dpp v80, v90, v4 row_newbcast:8 row_mask:0xf bank_mask:0xf
    v_and_b32_dpp v81, v90, v5 row_newbcast:8 row_mask:0xf bank_mask:0xf
    v_and_b32_dpp v82, v90, v6 row_newbcast:8 row_mask:0xf bank_mask:0xf
    v_and_b32_dpp v83, v90, v7 row_newbcast:8 row_mask:0xf bank_mask:0xf
    v_and_b32_dpp v84, v90, v4 row_newbcast:12 row_mask:0xf bank_mask:0xf
    v_and_b32_dpp v85, v90, v5 row_newbcast:12 row_mask:0xf bank_mask:0xf
    v_and_b32_dpp v86, v90, v6 row_newbcast:12 row_mask:0xf bank_mask:0xf
    v_and_b32_dpp v87, v90, v7 row_newbcast:12 row_mask:0xf bank_mask:0xf
    s_add_u32 s6, s58, 312
    s_and_b32 s6, s6, 511
    s_lshl_b32 s55, s6, 12
    s_waitcnt vmcnt(4)
    buffer_load_dwordx4 v[32:35], v12, s[8:11], s55 offen offset:0 nt
    buffer_load_dwordx4 v[36:39], v12, s[8:11], s55 offen offset:1024 nt
    buffer_load_dwordx4 v[40:43], v12, s[8:11], s55 offen offset:2048 nt
    buffer_load_dwordx4 v[44:47], v12, s[8:11], s55 offen offset:3072 nt
    v_mfma_f32_16x16x32_bf16 v[68:71], v[224:227], v[72:75], v[68:71]
    v_mfma_f32_16x16x32_bf16 v[68:71], v[228:231], v[76:79], v[68:71]
    v_mfma_f32_16x16x32_bf16 v[68:71], v[232:235], v[80:83], v[68:71]
    v_mfma_f32_16x16x32_bf16 v[68:71], v[236:239], v[84:87], v[68:71]
    v_sub_f32 v90, v120, v88
    v_exp_f32 v90, v90
    s_nop 0
    v_add_f32 v89, v89, v90
    v_cvt_pk_bf16_f32 v90, v90, v90
    s_nop 1
    v_and_b32_dpp v72, v90, v4 row_newbcast:0 row_mask:0xf bank_mask:0xf
    v_and_b32_dpp v73, v90, v5 row_newbcast:0 row_mask:0xf bank_mask:0xf
    v_and_b32_dpp v74, v90, v6 row_newbcast:0 row_mask:0xf bank_mask:0xf
    v_and_b32_dpp v75, v90, v7 row_newbcast:0 row_mask:0xf bank_mask:0xf
    v_and_b32_dpp v76, v90, v4 row_newbcast:4 row_mask:0xf bank_mask:0xf
    v_and_b32_dpp v77, v90, v5 row_newbcast:4 row_mask:0xf bank_mask:0xf
    v_and_b32_dpp v78, v90, v6 row_newbcast:4 row_mask:0xf bank_mask:0xf
    v_and_b32_dpp v79, v90, v7 row_newbcast:4 row_mask:0xf bank_mask:0xf
    v_and_b32_dpp v80, v90, v4 row_newbcast:8 row_mask:0xf bank_mask:0xf
    v_and_b32_dpp v81, v90, v5 row_newbcast:8 row_mask:0xf bank_mask:0xf
    v_and_b32_dpp v82, v90, v6 row_newbcast:8 row_mask:0xf bank_mask:0xf
    v_and_b32_dpp v83, v90, v7 row_newbcast:8 row_mask:0xf bank_mask:0xf
    v_and_b32_dpp v84, v90, v4 row_newbcast:12 row_mask:0xf bank_mask:0xf
    v_and_b32_dpp v85, v90, v5 row_newbcast:12 row_mask:0xf bank_mask:0xf
    v_and_b32_dpp v86, v90, v6 row_newbcast:12 row_mask:0xf bank_mask:0xf
    v_and_b32_dpp v87, v90, v7 row_newbcast:12 row_mask:0xf bank_mask:0xf
    s_add_u32 s6, s58, 312
    s_and_b32 s6, s6, 511
    s_lshl_b32 s55, s6, 12
    s_waitcnt vmcnt(4)
    buffer_load_dwordx4 v[48:51], v13, s[12:15], s55 offen offset:0 nt
    buffer_load_dwordx4 v[52:55], v13, s[12:15], s55 offen offset:1024 nt
    buffer_load_dwordx4 v[56:59], v13, s[12:15], s55 offen offset:2048 nt
    buffer_load_dwordx4 v[60:63], v13, s[12:15], s55 offen offset:3072 nt
    v_mfma_f32_16x16x32_bf16 v[68:71], v[240:243], v[72:75], v[68:71]
    v_mfma_f32_16x16x32_bf16 v[68:71], v[244:247], v[76:79], v[68:71]
    v_mfma_f32_16x16x32_bf16 v[68:71], v[248:251], v[80:83], v[68:71]
    v_mfma_f32_16x16x32_bf16 v[68:71], v[252:255], v[84:87], v[68:71]
    s_add_u32 s83, s83, 312
    s_mov_b32 s57, s83
    s_add_u32 s6, s57, s84
    s_sub_u32 s62, s6, 385
    s_cmp_lt_u32 s6, s85
    s_cbranch_scc1 L_nt_48
    s_mov_b32 s62, 1
    s_atomic_add s62, s[68:69], 0x0 glc
L_nt_48:

L_BLOOP:
    s_waitcnt lgkmcnt(0)
    s_add_u32 s57, s62, 385
    s_add_u32 s6, s57, s59
    s_and_b32 s6, s6, 511
    s_lshl_b32 s55, s6, 12
    s_cmp_lt_u32 s57, 512
    s_cbranch_scc0 L_BLAST
    s_waitcnt vmcnt(4)
    v_mfma_f32_16x16x32_bf16 v[64:67], v[32:35], v[16:19], 0
    v_mfma_f32_16x16x32_bf16 v[64:67], v[36:39], v[20:23], v[64:67]
    v_mfma_f32_16x16x32_bf16 v[64:67], v[40:43], v[24:27], v[64:67]
    v_mfma_f32_16x16x32_bf16 v[64:67], v[44:47], v[28:31], v[64:67]
    buffer_load_dwordx4 v[32:35], v12, s[8:11], s55 offen offset:0 nt
    buffer_load_dwordx4 v[36:39], v12, s[8:11], s55 offen offset:1024 nt
    buffer_load_dwordx4 v[40:43], v12, s[8:11], s55 offen offset:2048 nt
    buffer_load_dwordx4 v[44:47], v12, s[8:11], s55 offen offset:3072 nt
    s_cmp_ge_u32 s57, 400
    s_cbranch_scc1 L_BRET
    s_add_u32 s6, s57, s84
    s_sub_u32 s62, s6, 385
    s_cmp_lt_u32 s6, s85
    s_cbranch_scc1 L_nt_49
    s_mov_b32 s62, 1
    s_atomic_add s62, s[68:69], 0x0 glc
L_nt_49:
L_BRET:
    s_nop 1
    v_mov_b32_dpp v90, v64 quad_perm:[0,0,0,0] row_mask:0xf bank_mask:0xf
    s_nop 1
    v_add_f32_dpp v90, v65, v90 quad_perm:[1,1,1,1] row_mask:0xf bank_mask:0xf
    s_nop 1
    v_add_f32_dpp v90, v66, v90 quad_perm:[2,2,2,2] row_mask:0xf bank_mask:0xf
    s_nop 1
    v_add_f32_dpp v90, v67, v90 quad_perm:[3,3,3,3] row_mask:0xf bank_mask:0xf
    v_mul_f32 v90, s60, v90
    v_max_f32 v91, v90, v88
    s_nop 1
    v_max_f32_dpp v91, v91, v91 row_ror:4 row_mask:0xf bank_mask:0xf
    s_nop 1
    v_max_f32_dpp v91, v91, v91 row_ror:8 row_mask:0xf bank_mask:0xf
    v_mov_b32 v92, v91
    s_nop 1
    v_permlane16_swap_b32 v91, v92
    v_max_f32 v91, v91, v92
    v_mov_b32 v92, v91
    s_nop 1
    v_permlane32_swap_b32 v91, v92
    v_max_f32 v91, v91, v92
    v_sub_f32 v92, v88, v91
    v_sub_f32 v90, v90, v91
    v_exp_f32 v92, v92
    v_exp_f32 v90, v90
    v_mov_b32 v88, v91
    v_fma_f32 v89, v89, v92, v90
    v_cvt_pk_bf16_f32 v90, v90, v90
    v_mul_f32 v68, v68, v92
    v_mul_f32 v69, v69, v92
    v_mul_f32 v70, v70, v92
    v_mul_f32 v71, v71, v92
    v_and_b32_dpp v72, v90, v4 row_newbcast:0 row_mask:0xf bank_mask:0xf
    v_and_b32_dpp v73, v90, v5 row_newbcast:0 row_mask:0xf bank_mask:0xf
    v_and_b32_dpp v74, v90, v6 row_newbcast:0 row_mask:0xf bank_mask:0xf
    v_and_b32_dpp v75, v90, v7 row_newbcast:0 row_mask:0xf bank_mask:0xf
    v_and_b32_dpp v76, v90, v4 row_newbcast:4 row_mask:0xf bank_mask:0xf
    v_and_b32_dpp v77, v90, v5 row_newbcast:4 row_mask:0xf bank_mask:0xf
    v_and_b32_dpp v78, v90, v6 row_newbcast:4 row_mask:0xf bank_mask:0xf
    v_and_b32_dpp v79, v90, v7 row_newbcast:4 row_mask:0xf bank_mask:0xf
    v_and_b32_dpp v80, v90, v4 row_newbcast:8 row_mask:0xf bank_mask:0xf
    v_and_b32_dpp v81, v90, v5 row_newbcast:8 row_mask:0xf bank_mask:0xf
    v_and_b32_dpp v82, v90, v6 row_newbcast:8 row_mask:0xf bank_mask:0xf
    v_and_b32_dpp v83, v90, v7 row_newbcast:8 row_mask:0xf bank_mask:0xf
    v_and_b32_dpp v84, v90, v4 row_newbcast:12 row_mask:0xf bank_mask:0xf
    v_and_b32_dpp v85, v90, v5 row_newbcast:12 row_mask:0xf bank_mask:0xf
    v_and_b32_dpp v86, v90, v6 row_newbcast:12 row_mask:0xf bank_mask:0xf
    v_and_b32_dpp v87, v90, v7 row_newbcast:12 row_mask:0xf bank_mask:0xf
    s_waitcnt vmcnt(4)
    v_mfma_f32_16x16x32_bf16 v[68:71], v[48:51], v[72:75], v[68:71]
    buffer_load_dwordx4 v[48:51], v13, s[12:15], s55 offen offset:0 nt
    v_mfma_f32_16x16x32_bf16 v[68:71], v[52:55], v[76:79], v[68:71]
    buffer_load_dwordx4 v[52:55], v13, s[12:15], s55 offen offset:1024 nt
    v_mfma_f32_16x16x32_bf16 v[68:71], v[56:59], v[80:83], v[68:71]
    buffer_load_dwordx4 v[56:59], v13, s[12:15], s55 offen offset:2048 nt
    v_mfma_f32_16x16x32_bf16 v[68:71], v[60:63], v[84:87], v[68:71]
    buffer_load_dwordx4 v[60:63], v13, s[12:15], s55 offen offset:3072 nt
    s_cmp_lt_u32 s57, 400
    s_cbranch_scc1 L_BL8
    s_add_u32 s6, s57, s84
    s_sub_u32 s62, s6, 385
    s_cmp_lt_u32 s6, s85
    s_cbranch_scc1 L_nt_50
    s_mov_b32 s62, 1
    s_atomic_add s62, s[68:69], 0x0 glc
L_nt_50:
L_BL8:
    s_branch L_BLOOP

L_BLAST:
    v_mov_b32 v93, 1
    s_mov_b64 exec, 1
    ds_add_u32 v1, v93 offset:28
    s_mov_b64 exec, -1
    s_waitcnt vmcnt(4)
    v_mfma_f32_16x16x32_bf16 v[64:67], v[32:35], v[16:19], 0
    v_mfma_f32_16x16x32_bf16 v[64:67], v[36:39], v[20:23], v[64:67]
    v_mfma_f32_16x16x32_bf16 v[64:67], v[40:43], v[24:27], v[64:67]
    v_mfma_f32_16x16x32_bf16 v[64:67], v[44:47], v[28:31], v[64:67]
    s_nop 7
    v_mov_b32_dpp v90, v64 quad_perm:[0,0,0,0] row_mask:0xf bank_mask:0xf
    s_nop 1
    v_add_f32_dpp v90, v65, v90 quad_perm:[1,1,1,1] row_mask:0xf bank_mask:0xf
    s_nop 1
    v_add_f32_dpp v90, v66, v90 quad_perm:[2,2,2,2] row_mask:0xf bank_mask:0xf
    s_nop 1
    v_add_f32_dpp v90, v67, v90 quad_perm:[3,3,3,3] row_mask:0xf bank_mask:0xf
    v_mul_f32 v90, s60, v90
    v_max_f32 v91, v90, v88
    s_nop 1
    v_max_f32_dpp v91, v91, v91 row_ror:4 row_mask:0xf bank_mask:0xf
    s_nop 1
    v_max_f32_dpp v91, v91, v91 row_ror:8 row_mask:0xf bank_mask:0xf
    v_mov_b32 v92, v91
    s_nop 1
    v_permlane16_swap_b32 v91, v92
    v_max_f32 v91, v91, v92
    v_mov_b32 v92, v91
    s_nop 1
    v_permlane32_swap_b32 v91, v92
    v_max_f32 v91, v91, v92
    v_sub_f32 v92, v88, v91
    v_sub_f32 v90, v90, v91
    v_exp_f32 v92, v92
    v_exp_f32 v90, v90
    v_mov_b32 v88, v91
    v_fma_f32 v89, v89, v92, v90
    v_cvt_pk_bf16_f32 v90, v90, v90
    v_mul_f32 v68, v68, v92
    v_mul_f32 v69, v69, v92
    v_mul_f32 v70, v70, v92
    v_mul_f32 v71, v71, v92
    v_and_b32_dpp v72, v90, v4 row_newbcast:0 row_mask:0xf bank_mask:0xf
    v_and_b32_dpp v73, v90, v5 row_newbcast:0 row_mask:0xf bank_mask:0xf
    v_and_b32_dpp v74, v90, v6 row_newbcast:0 row_mask:0xf bank_mask:0xf
    v_and_b32_dpp v75, v90, v7 row_newbcast:0 row_mask:0xf bank_mask:0xf
    v_and_b32_dpp v76, v90, v4 row_newbcast:4 row_mask:0xf bank_mask:0xf
    v_and_b32_dpp v77, v90, v5 row_newbcast:4 row_mask:0xf bank_mask:0xf
    v_and_b32_dpp v78, v90, v6 row_newbcast:4 row_mask:0xf bank_mask:0xf
    v_and_b32_dpp v79, v90, v7 row_newbcast:4 row_mask:0xf bank_mask:0xf
    v_and_b32_dpp v80, v90, v4 row_newbcast:8 row_mask:0xf bank_mask:0xf
    v_and_b32_dpp v81, v90, v5 row_newbcast:8 row_mask:0xf bank_mask:0xf
    v_and_b32_dpp v82, v90, v6 row_newbcast:8 row_mask:0xf bank_mask:0xf
    v_and_b32_dpp v83, v90, v7 row_newbcast:8 row_mask:0xf bank_mask:0xf
    v_and_b32_dpp v84, v90, v4 row_newbcast:12 row_mask:0xf bank_mask:0xf
    v_and_b32_dpp v85, v90, v5 row_newbcast:12 row_mask:0xf bank_mask:0xf
    v_and_b32_dpp v86, v90, v6 row_newbcast:12 row_mask:0xf bank_mask:0xf
    v_and_b32_dpp v87, v90, v7 row_newbcast:12 row_mask:0xf bank_mask:0xf
    s_waitcnt vmcnt(0)
    v_mfma_f32_16x16x32_bf16 v[68:71], v[48:51], v[72:75], v[68:71]
    v_add_f32_dpp v89, v89, v89 row_ror:4 row_mask:0xf bank_mask:0xf
    v_mfma_f32_16x16x32_bf16 v[68:71], v[52:55], v[76:79], v[68:71]
    s_nop 0
    v_add_f32_dpp v89, v89, v89 row_ror:8 row_mask:0xf bank_mask:0xf
    v_mfma_f32_16x16x32_bf16 v[68:71], v[56:59], v[80:83], v[68:71]
    v_mov_b32 v92, v89
    v_mfma_f32_16x16x32_bf16 v[68:71], v[60:63], v[84:87], v[68:71]
    s_nop 0
    v_permlane16_swap_b32 v89, v92
    v_add_f32 v89, v89, v92
    v_mov_b32 v92, v89
    s_nop 1
    v_permlane32_swap_b32 v89, v92
    v_add_f32 v89, v89, v92
    ds_write_b64 v15, v[88:89] offset:4608
    ds_write_b128 v14, v[68:71] offset:2560
    s_mov_b64 exec, 1
    ds_add_rtn_u32 v94, v1, v93 offset:8
    s_mov_b64 exec, -1
    ds_read_b32 v92, v1 offset:24
    ds_read_b128 v[16:19], v1 offset:4608
    ds_read_b128 v[20:23], v1 offset:4624
    ds_read_b64 v[24:25], v96 offset:2560
    ds_read_b64 v[26:27], v96 offset:3072
    ds_read_b64 v[28:29], v96 offset:3584
    ds_read_b64 v[30:31], v96 offset:4096
    s_waitcnt lgkmcnt(0)
    v_readfirstlane_b32 s6, v92
    v_readfirstlane_b32 s7, v94
    v_max3_f32 v8, v16, v18, v20
    s_cmp_lg_u32 s6, 0
    s_cbranch_scc1 L_BL_m
L_lw_51:
    ds_read_b32 v92, v1 offset:24
    s_waitcnt lgkmcnt(0)
    v_readfirstlane_b32 s6, v92
    s_nop 0
    s_cmp_ge_u32 s6, 1
    s_cbranch_scc1 L_lwd_52
    s_sleep 1
    s_add_u32 s52, s52, 1
    s_cmp_lt_u32 s52, 400000
    s_cbranch_scc1 L_lw_51
L_lwd_52:
L_BL_m:
    s_cmp_lg_u32 s7, 3
    s_cbranch_scc1 L_BL_np
    v_max_f32 v8, v22, v8
    v_sub_f32 v16, v16, v8
    v_sub_f32 v18, v18, v8
    v_sub_f32 v20, v20, v8
    v_sub_f32 v22, v22, v8
    v_exp_f32 v16, v16
    v_exp_f32 v18, v18
    v_exp_f32 v20, v20
    v_exp_f32 v22, v22
    v_mul_f32 v10, v16, v24
    v_mul_f32 v11, v16, v25
    v_fmac_f32 v10, v18, v26
    v_fmac_f32 v11, v18, v27
    v_fmac_f32 v10, v20, v28
    v_fmac_f32 v11, v20, v29
    v_fmac_f32 v10, v22, v30
    v_fmac_f32 v11, v22, v31
    v_cvt_pk_bf16_f32 v10, v10, v11
    v_min_u32 v10, -2, v10
    buffer_store_dword v10, v97, s[44:47], 0 offen sc1
    v_mul_f32 v9, v16, v17
    v_fmac_f32 v9, v18, v19
    v_fmac_f32 v9, v20, v21
    v_fmac_f32 v9, v22, v23
    v_min_u32 v8, -2, v8
    v_min_u32 v9, -2, v9
    buffer_store_dwordx2 v[8:9], v98, s[44:47], 0 offen offset:256 sc1
    ds_write_b32 v1, v1 offset:36
    s_branch L_BL_d
L_BL_np:
L_BL_d:
    s_lshl_b32 s6, s7, 15
    s_add_u32 s80, s80, s6
    s_add_u32 s63, s63, s6
    s_lshl_b32 s81, s7, 12
    s_add_u32 m0, s81, 0x4000
    s_add_u32 s6, s80, 0x0
    buffer_load_dwordx4 v104, s[72:75], s6 offen  lds
    s_add_u32 m0, s81, 0x4400
    s_add_u32 s6, s80, 0x2000
    buffer_load_dwordx4 v105, s[72:75], s6 offen  lds
    s_add_u32 m0, s81, 0x4800
    s_add_u32 s6, s80, 0x4000
    buffer_load_dwordx4 v106, s[72:75], s6 offen  lds
    s_add_u32 m0, s81, 0x4c00
    s_add_u32 s6, s80, 0x6000
    buffer_load_dwordx4 v107, s[72:75], s6 offen  lds
    s_add_u32 m0, s81, 0x0
    s_add_u32 s6, s63, 0x0
    buffer_load_dwordx4 v104, s[76:79], s6 offen  lds
    s_add_u32 m0, s81, 0x400
    s_add_u32 s6, s63, 0x2000
    buffer_load_dwordx4 v105, s[76:79], s6 offen  lds
    s_add_u32 m0, s81, 0x800
    s_add_u32 s6, s63, 0x4000
    buffer_load_dwordx4 v106, s[76:79], s6 offen  lds
    s_add_u32 m0, s81, 0xc00
    s_add_u32 s6, s63, 0x6000
    buffer_load_dwordx4 v107, s[76:79], s6 offen  lds
    s_lshl_b32 s6, s7, 2
    v_add_u32 v94, s6, v1
    s_mov_b64 exec, 1
    s_waitcnt vmcnt(4)
    ds_add_u32 v94, v93 offset:48
    s_waitcnt vmcnt(0)
    ds_add_u32 v94, v93 offset:48
    s_mov_b64 exec, -1
    s_cmp_ge_u32 s7, 2
    s_cbranch_scc1 L_BL_e
    s_add_u32 s82, s7, 0
    s_lshr_b32 s6, s2, 3
    s_xor_b32 s6, s6, s82
    s_add_u32 s6, s6, s5
    s_and_b32 s6, s6, 31
    s_xor_b32 s6, s6, s4
    s_lshl_b32 s6, s6, 17
    s_xor_b32 s80, s80, s6
    s_lshl_b32 s6, s82, 17
    s_xor_b32 s63, s63, s6
    s_or_b32 s80, s80, 0x18000
    s_or_b32 s63, s63, 0x18000
    s_add_u32 s6, s80, 0x0
    buffer_load_dwordx4 v[128:131], v104, s[72:75], s6 offen
    s_add_u32 s6, s80, 0x2000
    buffer_load_dwordx4 v[128:131], v104, s[72:75], s6 offen
    s_add_u32 s6, s80, 0x4000
    buffer_load_dwordx4 v[128:131], v104, s[72:75], s6 offen
    s_add_u32 s6, s80, 0x6000
    buffer_load_dwordx4 v[128:131], v104, s[72:75], s6 offen
    s_add_u32 s6, s63, 0x0
    buffer_load_dwordx4 v[128:131], v104, s[76:79], s6 offen
    s_add_u32 s6, s63, 0x2000
    buffer_load_dwordx4 v[128:131], v104, s[76:79], s6 offen
    s_add_u32 s6, s63, 0x4000
    buffer_load_dwordx4 v[128:131], v104, s[76:79], s6 offen
    s_add_u32 s6, s63, 0x6000
    buffer_load_dwordx4 v[128:131], v104, s[76:79], s6 offen
L_BL_e:
    s_endpgm

L_ATT:
    s_mov_b32 s64, s18
    s_mov_b32 s65, s19
    s_mov_b32 s66, 0x800000
    s_mov_b32 s67, 0x20000
    s_lshr_b32 s6, s53, 2
    s_lshl_b32 s54, s4, 1
    s_add_u32 s54, s54, s6
    s_lshl_b32 s56, s3, 15
    s_lshl_b32 s57, s54, 17
    s_add_u32 s57, s57, s56
    s_add_u32 s70, s3, s54
    s_and_b32 s70, s70, 3
    s_and_b32 s6, s70, 1
    s_lshl_b32 s6, s6, 5
    s_lshl_b32 s70, s70, 13
    v_xor_b32 v47, s6, v13
    v_xor_b32 v64, 0, v47
    v_xor_b32 v65, 16, v47
    v_xor_b32 v66, 32, v47
    v_xor_b32 v67, 48, v47
    v_xor_b32 v68, 64, v47
    v_xor_b32 v69, 80, v47
    v_xor_b32 v70, 96, v47
    v_xor_b32 v71, 112, v47
    v_xor_b32 v72, 128, v47
    v_xor_b32 v73, 144, v47
    v_xor_b32 v74, 160, v47
    v_xor_b32 v75, 176, v47
    v_xor_b32 v76, 192, v47
    v_xor_b32 v77, 208, v47
    v_xor_b32 v78, 224, v47
    v_xor_b32 v79, 240, v47
    s_barrier
    s_add_u32 m0, s56, s70
    s_add_u32 s71, s57, s70
    buffer_load_dwordx4 v64, s[64:67], s71 offen offset:0  lds
    buffer_load_dwordx4 v68, s[64:67], s71 offen offset:1024  lds
    buffer_load_dwordx4 v72, s[64:67], s71 offen offset:2048  lds
    buffer_load_dwordx4 v76, s[64:67], s71 offen offset:3072  lds
    s_add_u32 s70, s70, 0x1000
    s_and_b32 s70, s70, 0x7fff
    s_add_u32 m0, s56, s70
    s_add_u32 s71, s57, s70
    buffer_load_dwordx4 v65, s[64:67], s71 offen offset:0  lds
    buffer_load_dwordx4 v69, s[64:67], s71 offen offset:1024  lds
    buffer_load_dwordx4 v73, s[64:67], s71 offen offset:2048  lds
    buffer_load_dwordx4 v77, s[64:67], s71 offen offset:3072  lds
    s_add_u32 s70, s70, 0x1000
    s_and_b32 s70, s70, 0x7fff
    s_add_u32 m0, s56, s70
    s_add_u32 s71, s57, s70
    s_waitcnt vmcnt(7)
    buffer_load_dwordx4 v66, s[64:67], s71 offen offset:0  lds
    s_waitcnt vmcnt(7)
    buffer_load_dwordx4 v70, s[64:67], s71 offen offset:1024  lds
    s_waitcnt vmcnt(7)
    buffer_load_dwordx4 v74, s[64:67], s71 offen offset:2048  lds
    s_waitcnt vmcnt(7)
    buffer_load_dwordx4 v78, s[64:67], s71 offen offset:3072  lds
    s_add_u32 s70, s70, 0x1000
    s_and_b32 s70, s70, 0x7fff
    s_add_u32 m0, s56, s70
    s_add_u32 s71, s57, s70
    s_waitcnt vmcnt(7)
    buffer_load_dwordx4 v67, s[64:67], s71 offen offset:0  lds
    s_waitcnt vmcnt(7)
    buffer_load_dwordx4 v71, s[64:67], s71 offen offset:1024  lds
    s_waitcnt vmcnt(7)
    buffer_load_dwordx4 v75, s[64:67], s71 offen offset:2048  lds
    s_waitcnt vmcnt(7)
    buffer_load_dwordx4 v79, s[64:67], s71 offen offset:3072  lds
    s_add_u32 s70, s70, 0x1000
    s_and_b32 s70, s70, 0x7fff
    s_add_u32 m0, s56, s70
    s_add_u32 s71, s57, s70
    s_waitcnt vmcnt(7)
    buffer_load_dwordx4 v64, s[64:67], s71 offen offset:0  lds
    s_waitcnt vmcnt(7)
    buffer_load_dwordx4 v68, s[64:67], s71 offen offset:1024  lds
    s_waitcnt vmcnt(7)
    buffer_load_dwordx4 v72, s[64:67], s71 offen offset:2048  lds
    s_waitcnt vmcnt(7)
    buffer_load_dwordx4 v76, s[64:67], s71 offen offset:3072  lds
    s_add_u32 s70, s70, 0x1000
    s_and_b32 s70, s70, 0x7fff
    s_add_u32 m0, s56, s70
    s_add_u32 s71, s57, s70
    s_waitcnt vmcnt(7)
    buffer_load_dwordx4 v65, s[64:67], s71 offen offset:0  lds
    s_waitcnt vmcnt(7)
    buffer_load_dwordx4 v69, s[64:67], s71 offen offset:1024  lds
    s_waitcnt vmcnt(7)
    buffer_load_dwordx4 v73, s[64:67], s71 offen offset:2048  lds
    s_waitcnt vmcnt(7)
    buffer_load_dwordx4 v77, s[64:67], s71 offen offset:3072  lds
    s_add_u32 s70, s70, 0x1000
    s_and_b32 s70, s70, 0x7fff
    s_add_u32 m0, s56, s70
    s_add_u32 s71, s57, s70
    s_waitcnt vmcnt(7)
    buffer_load_dwordx4 v66, s[64:67], s71 offen offset:0  lds
    s_waitcnt vmcnt(7)
    buffer_load_dwordx4 v70, s[64:67], s71 offen offset:1024  lds
    s_waitcnt vmcnt(7)
    buffer_load_dwordx4 v74, s[64:67], s71 offen offset:2048  lds
    s_waitcnt vmcnt(7)
    buffer_load_dwordx4 v78, s[64:67], s71 offen offset:3072  lds
    s_add_u32 s70, s70, 0x1000
    s_and_b32 s70, s70, 0x7fff
    s_add_u32 m0, s56, s70
    s_add_u32 s71, s57, s70
    s_waitcnt vmcnt(7)
    buffer_load_dwordx4 v67, s[64:67], s71 offen offset:0  lds
    s_waitcnt vmcnt(7)
    buffer_load_dwordx4 v71, s[64:67], s71 offen offset:1024  lds
    s_waitcnt vmcnt(7)
    buffer_load_dwordx4 v75, s[64:67], s71 offen offset:2048  lds
    s_waitcnt vmcnt(7)
    buffer_load_dwordx4 v79, s[64:67], s71 offen offset:3072  lds
    v_and_b32 v40, 3, v0
    v_lshlrev_b32 v40, 2, v40
    v_bfe_u32 v41, v0, 2, 2
    v_or_b32 v40, v40, v41
    v_lshrrev_b32 v41, 5, v0
    v_xor_b32 v40, v40, v41
    v_and_b32 v42, 31, v0
    s_lshl_b32 s56, s3, 15
    v_lshlrev_b32 v43, 10, v42
    v_add_u32 v43, s56, v43
    v_lshlrev_b32 v44, 9, v42
    v_add_u32 v44, 0x20000, v44
    v_xor_b32 v45, 0, v40
    v_lshl_add_u32 v32, v45, 4, v43
    v_lshl_add_u32 v4, v45, 4, v44
    v_xor_b32 v45, 2, v40
    v_lshl_add_u32 v33, v45, 4, v43
    v_lshl_add_u32 v5, v45, 4, v44
    v_xor_b32 v45, 4, v40
    v_lshl_add_u32 v34, v45, 4, v43
    v_lshl_add_u32 v6, v45, 4, v44
    v_xor_b32 v45, 6, v40
    v_lshl_add_u32 v35, v45, 4, v43
    v_lshl_add_u32 v7, v45, 4, v44
    v_xor_b32 v45, 8, v40
    v_lshl_add_u32 v36, v45, 4, v43
    v_lshl_add_u32 v8, v45, 4, v44
    v_xor_b32 v45, 10, v40
    v_lshl_add_u32 v37, v45, 4, v43
    v_lshl_add_u32 v9, v45, 4, v44
    v_xor_b32 v45, 12, v40
    v_lshl_add_u32 v38, v45, 4, v43
    v_lshl_add_u32 v10, v45, 4, v44
    v_xor_b32 v45, 14, v40
    v_lshl_add_u32 v39, v45, 4, v43
    v_lshl_add_u32 v11, v45, 4, v44
    s_lshl_b32 s6, s3, 3
    v_add_u32 v45, s6, v41
    v_mul_u32_u24 v14, 0x5300, v45
    v_lshl_add_u32 v14, v42, 4, v14
    v_add_u32 v14, 0x2400, v14
    v_add_u32 v46, 0, v45
    v_and_b32 v47, 3, v46
    v_lshlrev_b32 v47, 2, v47
    v_bfe_u32 v15, v46, 2, 2
    v_or_b32 v47, v47, v15
    v_xor_b32 v47, v47, v42
    v_lshlrev_b32 v46, 9, v46
    v_lshl_add_u32 v28, v47, 4, v46
    v_add_u32 v28, 0x20000, v28
    v_add_u32 v46, 2, v45
    v_and_b32 v47, 3, v46
    v_lshlrev_b32 v47, 2, v47
    v_bfe_u32 v15, v46, 2, 2
    v_or_b32 v47, v47, v15
    v_xor_b32 v47, v47, v42
    v_lshlrev_b32 v46, 9, v46
    v_lshl_add_u32 v29, v47, 4, v46
    v_add_u32 v29, 0x20000, v29
    v_add_u32 v46, 4, v45
    v_and_b32 v47, 3, v46
    v_lshlrev_b32 v47, 2, v47
    v_bfe_u32 v15, v46, 2, 2
    v_or_b32 v47, v47, v15
    v_xor_b32 v47, v47, v42
    v_lshlrev_b32 v46, 9, v46
    v_lshl_add_u32 v30, v47, 4, v46
    v_add_u32 v30, 0x20000, v30
    v_add_u32 v46, 6, v45
    v_and_b32 v47, 3, v46
    v_lshlrev_b32 v47, 2, v47
    v_bfe_u32 v15, v46, 2, 2
    v_or_b32 v47, v47, v15
    v_xor_b32 v47, v47, v42
    v_lshlrev_b32 v46, 9, v46
    v_lshl_add_u32 v31, v47, 4, v46
    v_add_u32 v31, 0x20000, v31
    v_mov_b32 v47, 0
    v_lshlrev_b32 v46, 2, v0
L_rc_53:
    v_cmp_eq_u32 vcc, 0, v47
    s_nop 0
    s_cmp_eq_u64 vcc, 0
    s_cbranch_scc1 L_rcd_54
    global_load_dword v47, v46, s[40:41] sc1
    s_waitcnt vmcnt(0)
    s_add_u32 s52, s52, 1
    s_cmp_lt_u32 s52, 400000
    s_cbranch_scc1 L_rc_53
L_rcd_54:
    ds_read_b128 v[128:131], v32 offset:0
    ds_read_b128 v[132:135], v33 offset:0
    ds_read_b128 v[136:139], v34 offset:0
    ds_read_b128 v[140:143], v35 offset:0
    ds_read_b128 v[144:147], v36 offset:0
    ds_read_b128 v[148:151], v37 offset:0
    ds_read_b128 v[152:155], v38 offset:0
    ds_read_b128 v[156:159], v39 offset:0
    s_waitcnt lgkmcnt(0)
    ds_read_b128 v[160:163], v32 offset:256
    ds_read_b128 v[164:167], v33 offset:256
    ds_read_b128 v[168:171], v34 offset:256
    ds_read_b128 v[172:175], v35 offset:256
    ds_read_b128 v[176:179], v36 offset:256
    ds_read_b128 v[180:183], v37 offset:256
    ds_read_b128 v[184:187], v38 offset:256
    ds_read_b128 v[188:191], v39 offset:256
    s_waitcnt lgkmcnt(0)
    ds_read_b128 v[192:195], v32 offset:512
    ds_read_b128 v[196:199], v33 offset:512
    ds_read_b128 v[200:203], v34 offset:512
    ds_read_b128 v[204:207], v35 offset:512
    ds_read_b128 v[208:211], v36 offset:512
    ds_read_b128 v[212:215], v37 offset:512
    ds_read_b128 v[216:219], v38 offset:512
    ds_read_b128 v[220:223], v39 offset:512
    s_waitcnt lgkmcnt(0)
    ds_read_b128 v[224:227], v32 offset:768
    ds_read_b128 v[228:231], v33 offset:768
    ds_read_b128 v[232:235], v34 offset:768
    ds_read_b128 v[236:239], v35 offset:768
    ds_read_b128 v[240:243], v36 offset:768
    ds_read_b128 v[244:247], v37 offset:768
    ds_read_b128 v[248:251], v38 offset:768
    ds_read_b128 v[252:255], v39 offset:768
    s_waitcnt lgkmcnt(0)
    s_add_u32 s61, s83, s59
    s_lshl_b32 s6, s3, 11
    v_lshl_add_u32 v84, v0, 2, v1
    v_add_u32 v84, s6, v84
    s_add_u32 s6, s61, 0
    s_and_b32 s6, s6, 511
    s_lshl_b32 s55, s6, 12
    buffer_load_dwordx4 v[112:115], v12, s[8:11], s55 offen offset:0 nt
    buffer_load_dwordx4 v[116:119], v12, s[8:11], s55 offen offset:1024 nt
    buffer_load_dwordx4 v[120:123], v12, s[8:11], s55 offen offset:2048 nt
    buffer_load_dwordx4 v[124:127], v12, s[8:11], s55 offen offset:3072 nt
    s_add_u32 s6, s61, 8
    s_and_b32 s6, s6, 511
    s_lshl_b32 s55, s6, 12
    buffer_load_dwordx4 v[32:35], v12, s[8:11], s55 offen offset:0 nt
    buffer_load_dwordx4 v[36:39], v12, s[8:11], s55 offen offset:1024 nt
    buffer_load_dwordx4 v[40:43], v12, s[8:11], s55 offen offset:2048 nt
    buffer_load_dwordx4 v[44:47], v12, s[8:11], s55 offen offset:3072 nt
    s_add_u32 s6, s61, 16
    s_and_b32 s6, s6, 511
    s_lshl_b32 s55, s6, 12
    s_waitcnt vmcnt(4)
    buffer_load_dwordx4 v[48:51], v12, s[8:11], s55 offen offset:0 nt
    buffer_load_dwordx4 v[52:55], v12, s[8:11], s55 offen offset:1024 nt
    buffer_load_dwordx4 v[56:59], v12, s[8:11], s55 offen offset:2048 nt
    buffer_load_dwordx4 v[60:63], v12, s[8:11], s55 offen offset:3072 nt
    s_add_u32 s6, s61, 24
    s_and_b32 s6, s6, 511
    s_lshl_b32 s55, s6, 12
    s_waitcnt vmcnt(4)
    buffer_load_dwordx4 v[96:99], v12, s[8:11], s55 offen offset:0 nt
    buffer_load_dwordx4 v[100:103], v12, s[8:11], s55 offen offset:1024 nt
    buffer_load_dwordx4 v[104:107], v12, s[8:11], s55 offen offset:2048 nt
    buffer_load_dwordx4 v[108:111], v12, s[8:11], s55 offen offset:3072 nt
L_lw_55:
    ds_read_b32 v15, v1 offset:0
    s_waitcnt lgkmcnt(0)
    v_readfirstlane_b32 s6, v15
    s_nop 0
    s_cmp_ge_u32 s6, 1
    s_cbranch_scc1 L_lwd_56
    s_sleep 1
    s_add_u32 s52, s52, 1
    s_cmp_lt_u32 s52, 400000
    s_cbranch_scc1 L_lw_55
L_lwd_56:
    v_and_b32 v15, 3, v0
    v_lshl_add_u32 v15, v2, 2, v15
    v_lshl_add_u32 v15, v15, 4, v1
    ds_read_b128 v[88:91], v15 offset:256
    v_lshrrev_b32 v15, 2, v3
    s_waitcnt lgkmcnt(0)
    v_cmp_eq_u32 vcc, 0, v15
    s_nop 1
    v_cndmask_b32 v64, 0, v88, vcc
    v_cndmask_b32 v65, 0, v89, vcc
    v_cndmask_b32 v66, 0, v90, vcc
    v_cndmask_b32 v67, 0, v91, vcc
    v_cmp_eq_u32 vcc, 1, v15
    s_nop 1
    v_cndmask_b32 v68, 0, v88, vcc
    v_cndmask_b32 v69, 0, v89, vcc
    v_cndmask_b32 v70, 0, v90, vcc
    v_cndmask_b32 v71, 0, v91, vcc
    v_cmp_eq_u32 vcc, 2, v15
    s_nop 1
    v_cndmask_b32 v72, 0, v88, vcc
    v_cndmask_b32 v73, 0, v89, vcc
    v_cndmask_b32 v74, 0, v90, vcc
    v_cndmask_b32 v75, 0, v91, vcc
    v_cmp_eq_u32 vcc, 3, v15
    s_nop 1
    v_cndmask_b32 v76, 0, v88, vcc
    v_cndmask_b32 v77, 0, v89, vcc
    v_cndmask_b32 v78, 0, v90, vcc
    v_cndmask_b32 v79, 0, v91, vcc
    v_mfma_f32_16x16x32_bf16 v[80:83], v[112:115], v[64:67], 0
    v_mfma_f32_16x16x32_bf16 v[80:83], v[116:119], v[68:71], v[80:83]
    v_mfma_f32_16x16x32_bf16 v[80:83], v[120:123], v[72:75], v[80:83]
    v_mfma_f32_16x16x32_bf16 v[80:83], v[124:127], v[76:79], v[80:83]
    s_nop 7
    v_mov_b32_dpp v85, v80 quad_perm:[0,0,0,0] row_mask:0xf bank_mask:0xf
    s_nop 1
    v_add_f32_dpp v85, v81, v85 quad_perm:[1,1,1,1] row_mask:0xf bank_mask:0xf
    s_nop 1
    v_add_f32_dpp v85, v82, v85 quad_perm:[2,2,2,2] row_mask:0xf bank_mask:0xf
    s_nop 1
    v_add_f32_dpp v85, v83, v85 quad_perm:[3,3,3,3] row_mask:0xf bank_mask:0xf
    ds_write_b32 v84, v85 offset:5120
    v_mfma_f32_16x16x32_bf16 v[80:83], v[32:35], v[64:67], 0
    v_mfma_f32_16x16x32_bf16 v[80:83], v[36:39], v[68:71], v[80:83]
    v_mfma_f32_16x16x32_bf16 v[80:83], v[40:43], v[72:75], v[80:83]
    v_mfma_f32_16x16x32_bf16 v[80:83], v[44:47], v[76:79], v[80:83]
    s_nop 7
    v_mov_b32_dpp v85, v80 quad_perm:[0,0,0,0] row_mask:0xf bank_mask:0xf
    s_nop 1
    v_add_f32_dpp v85, v81, v85 quad_perm:[1,1,1,1] row_mask:0xf bank_mask:0xf
    s_nop 1
    v_add_f32_dpp v85, v82, v85 quad_perm:[2,2,2,2] row_mask:0xf bank_mask:0xf
    s_nop 1
    v_add_f32_dpp v85, v83, v85 quad_perm:[3,3,3,3] row_mask:0xf bank_mask:0xf
    ds_write_b32 v84, v85 offset:5376
    s_add_u32 s6, s61, 32
    s_and_b32 s6, s6, 511
    s_lshl_b32 s55, s6, 12
    s_waitcnt vmcnt(4)
    buffer_load_dwordx4 v[112:115], v12, s[8:11], s55 offen offset:0 nt
    buffer_load_dwordx4 v[116:119], v12, s[8:11], s55 offen offset:1024 nt
    buffer_load_dwordx4 v[120:123], v12, s[8:11], s55 offen offset:2048 nt
    buffer_load_dwordx4 v[124:127], v12, s[8:11], s55 offen offset:3072 nt
    v_mfma_f32_16x16x32_bf16 v[80:83], v[48:51], v[64:67], 0
    v_mfma_f32_16x16x32_bf16 v[80:83], v[52:55], v[68:71], v[80:83]
    v_mfma_f32_16x16x32_bf16 v[80:83], v[56:59], v[72:75], v[80:83]
    v_mfma_f32_16x16x32_bf16 v[80:83], v[60:63], v[76:79], v[80:83]
    s_nop 7
    v_mov_b32_dpp v85, v80 quad_perm:[0,0,0,0] row_mask:0xf bank_mask:0xf
    s_nop 1
    v_add_f32_dpp v85, v81, v85 quad_perm:[1,1,1,1] row_mask:0xf bank_mask:0xf
    s_nop 1
    v_add_f32_dpp v85, v82, v85 quad_perm:[2,2,2,2] row_mask:0xf bank_mask:0xf
    s_nop 1
    v_add_f32_dpp v85, v83, v85 quad_perm:[3,3,3,3] row_mask:0xf bank_mask:0xf
    ds_write_b32 v84, v85 offset:5632
    s_add_u32 s6, s61, 0
    s_and_b32 s6, s6, 511
    s_lshl_b32 s55, s6, 12
    s_waitcnt vmcnt(4)
    buffer_load_dwordx4 v[32:35], v13, s[12:15], s55 offen offset:0 nt
    buffer_load_dwordx4 v[36:39], v13, s[12:15], s55 offen offset:1024 nt
    buffer_load_dwordx4 v[40:43], v13, s[12:15], s55 offen offset:2048 nt
    buffer_load_dwordx4 v[44:47], v13, s[12:15], s55 offen offset:3072 nt
    v_mfma_f32_16x16x32_bf16 v[80:83], v[96:99], v[64:67], 0
    v_mfma_f32_16x16x32_bf16 v[80:83], v[100:103], v[68:71], v[80:83]
    v_mfma_f32_16x16x32_bf16 v[80:83], v[104:107], v[72:75], v[80:83]
    v_mfma_f32_16x16x32_bf16 v[80:83], v[108:111], v[76:79], v[80:83]
    s_nop 7
    v_mov_b32_dpp v85, v80 quad_perm:[0,0,0,0] row_mask:0xf bank_mask:0xf
    s_nop 1
    v_add_f32_dpp v85, v81, v85 quad_perm:[1,1,1,1] row_mask:0xf bank_mask:0xf
    s_nop 1
    v_add_f32_dpp v85, v82, v85 quad_perm:[2,2,2,2] row_mask:0xf bank_mask:0xf
    s_nop 1
    v_add_f32_dpp v85, v83, v85 quad_perm:[3,3,3,3] row_mask:0xf bank_mask:0xf
    ds_write_b32 v84, v85 offset:5888
    s_add_u32 s6, s61, 8
    s_and_b32 s6, s6, 511
    s_lshl_b32 s55, s6, 12
    s_waitcnt vmcnt(4)
    buffer_load_dwordx4 v[48:51], v13, s[12:15], s55 offen offset:0 nt
    buffer_load_dwordx4 v[52:55], v13, s[12:15], s55 offen offset:1024 nt
    buffer_load_dwordx4 v[56:59], v13, s[12:15], s55 offen offset:2048 nt
    buffer_load_dwordx4 v[60:63], v13, s[12:15], s55 offen offset:3072 nt
    v_mfma_f32_16x16x32_bf16 v[80:83], v[112:115], v[64:67], 0
    v_mfma_f32_16x16x32_bf16 v[80:83], v[116:119], v[68:71], v[80:83]
    v_mfma_f32_16x16x32_bf16 v[80:83], v[120:123], v[72:75], v[80:83]
    v_mfma_f32_16x16x32_bf16 v[80:83], v[124:127], v[76:79], v[80:83]
    s_nop 7
    v_mov_b32_dpp v85, v80 quad_perm:[0,0,0,0] row_mask:0xf bank_mask:0xf
    s_nop 1
    v_add_f32_dpp v85, v81, v85 quad_perm:[1,1,1,1] row_mask:0xf bank_mask:0xf
    s_nop 1
    v_add_f32_dpp v85, v82, v85 quad_perm:[2,2,2,2] row_mask:0xf bank_mask:0xf
    s_nop 1
    v_add_f32_dpp v85, v83, v85 quad_perm:[3,3,3,3] row_mask:0xf bank_mask:0xf
    ds_write_b32 v84, v85 offset:6144
    s_mov_b32 s56, 0x0
    s_mov_b32 s57, 0xa600
    s_mov_b32 s58, 0x14c00
    s_mov_b32 s59, 0x1f200
    s_cmp_eq_u32 s3, 0
    s_cbranch_scc0 L_ATT_w
    s_and_b32 s7, s54, 7
    s_lshl_b32 s7, s7, 8
    s_add_u32 s7, s7, 0x384040
L_sp_57:
    s_load_dword s6, s[42:43], s7 glc
    s_waitcnt lgkmcnt(0)
    s_cmp_ge_i32 s6, 31
    s_cbranch_scc1 L_spd_58
    s_sleep 4
    s_add_u32 s52, s52, 1
    s_cmp_lt_u32 s52, 400000
    s_cbranch_scc1 L_sp_57
L_spd_58:
    v_mov_b32 v15, 1
    s_mov_b64 exec, 1
    ds_add_u32 v1, v15 offset:32
    s_mov_b64 exec, -1
L_ATT_w:
L_lw_59:
    ds_read_b32 v15, v1 offset:32
    s_waitcnt lgkmcnt(0)
    v_readfirstlane_b32 s6, v15
    s_nop 0
    s_cmp_ge_u32 s6, 1
    s_cbranch_scc1 L_lwd_60
    s_sleep 1
    s_add_u32 s52, s52, 1
    s_cmp_lt_u32 s52, 400000
    s_cbranch_scc1 L_lw_59
L_lwd_60:
L_pl_61:
    buffer_load_dwordx4 v[96:99], v14, s[48:51], s56 offen offset:0 sc1
    buffer_load_dwordx4 v[100:103], v14, s[48:51], s57 offen offset:0 sc1
    buffer_load_dwordx4 v[104:107], v14, s[48:51], s58 offen offset:0 sc1
    buffer_load_dwordx4 v[108:111], v14, s[48:51], s59 offen offset:0 sc1
    buffer_load_dwordx4 v[112:115], v14, s[48:51], s56 offen offset:512 sc1
    buffer_load_dwordx4 v[116:119], v14, s[48:51], s57 offen offset:512 sc1
    buffer_load_dwordx4 v[120:123], v14, s[48:51], s58 offen offset:512 sc1
    buffer_load_dwordx4 v[124:127], v14, s[48:51], s59 offen offset:512 sc1
    s_waitcnt vmcnt(0)
L_plc_62:
    v_max_u32 v15, v96, v97
    v_max3_u32 v15, v98, v99, v15
    v_max3_u32 v15, v100, v101, v15
    v_max3_u32 v15, v102, v103, v15
    v_max3_u32 v15, v104, v105, v15
    v_max3_u32 v15, v106, v107, v15
    v_max3_u32 v15, v108, v109, v15
    v_max3_u32 v15, v110, v111, v15
    v_max3_u32 v15, v112, v113, v15
    v_max3_u32 v15, v114, v115, v15
    v_max3_u32 v15, v116, v117, v15
    v_max3_u32 v15, v118, v119, v15
    v_max3_u32 v15, v120, v121, v15
    v_max3_u32 v15, v122, v123, v15
    v_max3_u32 v15, v124, v125, v15
    v_max3_u32 v15, v126, v127, v15
    v_cmp_eq_u32 vcc, -1, v15
    s_nop 0
    s_and_b64 vcc, vcc, exec
    s_cbranch_scc0 L_pld_63
    s_mov_b64 exec, vcc
    s_sleep 4
    s_add_u32 s52, s52, 1
    s_cmp_lt_u32 s52, 400000
    s_cbranch_scc1 L_pl_61
L_pld_63:
    s_mov_b64 exec, -1
    ds_write_b128 v28, v[96:99]
    ds_write_b128 v29, v[100:103]
    ds_write_b128 v30, v[104:107]
    ds_write_b128 v31, v[108:111]
    s_waitcnt lgkmcnt(0)
    v_mov_b32 v15, 1
    s_mov_b64 exec, 1
    ds_add_u32 v1, v15 offset:12
    s_mov_b64 exec, -1
L_lw_64:
    ds_read_b32 v15, v1 offset:12
    s_waitcnt lgkmcnt(0)
    v_readfirstlane_b32 s6, v15
    s_nop 0
    s_cmp_ge_u32 s6, 4
    s_cbranch_scc1 L_lwd_65
    s_add_u32 s52, s52, 1
    s_cmp_lt_u32 s52, 400000
    s_cbranch_scc1 L_lw_64
L_lwd_65:
    v_mov_b32 v96, v28
    v_mov_b32 v97, v29
    v_mov_b32 v98, v30
    v_mov_b32 v99, v31
    ds_read_b128 v[64:67], v4
    ds_read_b128 v[68:71], v5
    ds_read_b128 v[72:75], v6
    ds_read_b128 v[76:79], v7
    ds_read_b128 v[80:83], v8
    ds_read_b128 v[84:87], v9
    ds_read_b128 v[88:91], v10
    ds_read_b128 v[92:95], v11 offset:0
    s_waitcnt lgkmcnt(7)
    v_mfma_f32_32x32x16_bf16 v[16:31], v[128:131], v[64:67], 0
    ds_read_b128 v[64:67], v4 offset:256
    s_waitcnt lgkmcnt(7)
    v_mfma_f32_32x32x16_bf16 v[16:31], v[132:135], v[68:71], v[16:31]
    ds_read_b128 v[68:71], v5 offset:256
    s_waitcnt lgkmcnt(7)
    v_mfma_f32_32x32x16_bf16 v[16:31], v[136:139], v[72:75], v[16:31]
    ds_read_b128 v[72:75], v6 offset:256
    s_waitcnt lgkmcnt(7)
    v_mfma_f32_32x32x16_bf16 v[16:31], v[140:143], v[76:79], v[16:31]
    ds_read_b128 v[76:79], v7 offset:256
    s_waitcnt lgkmcnt(7)
    v_mfma_f32_32x32x16_bf16 v[16:31], v[144:147], v[80:83], v[16:31]
    ds_read_b128 v[80:83], v8 offset:256
    s_waitcnt lgkmcnt(7)
    v_mfma_f32_32x32x16_bf16 v[16:31], v[148:151], v[84:87], v[16:31]
    ds_read_b128 v[84:87], v9 offset:256
    s_waitcnt lgkmcnt(7)
    v_mfma_f32_32x32x16_bf16 v[16:31], v[152:155], v[88:91], v[16:31]
    ds_read_b128 v[88:91], v10 offset:256
    s_waitcnt lgkmcnt(7)
    v_mfma_f32_32x32x16_bf16 v[16:31], v[156:159], v[92:95], v[16:31]
    ds_read_b128 v[92:95], v11 offset:256
    s_waitcnt lgkmcnt(7)
    v_mfma_f32_32x32x16_bf16 v[16:31], v[160:163], v[64:67], v[16:31]
    s_waitcnt lgkmcnt(6)
    v_mfma_f32_32x32x16_bf16 v[16:31], v[164:167], v[68:71], v[16:31]
    s_waitcnt lgkmcnt(5)
    v_mfma_f32_32x32x16_bf16 v[16:31], v[168:171], v[72:75], v[16:31]
    s_waitcnt lgkmcnt(4)
    v_mfma_f32_32x32x16_bf16 v[16:31], v[172:175], v[76:79], v[16:31]
    s_waitcnt lgkmcnt(3)
    v_mfma_f32_32x32x16_bf16 v[16:31], v[176:179], v[80:83], v[16:31]
    s_waitcnt lgkmcnt(2)
    v_mfma_f32_32x32x16_bf16 v[16:31], v[180:183], v[84:87], v[16:31]
    s_waitcnt lgkmcnt(1)
    v_mfma_f32_32x32x16_bf16 v[16:31], v[184:187], v[88:91], v[16:31]
    s_waitcnt lgkmcnt(0)
    v_mfma_f32_32x32x16_bf16 v[16:31], v[188:191], v[92:95], v[16:31]
    s_waitcnt lgkmcnt(0)
    v_mov_b32 v15, 1
    s_mov_b64 exec, 1
    ds_add_u32 v1, v15 offset:12
    s_mov_b64 exec, -1
L_lw_66:
    ds_read_b32 v15, v1 offset:12
    s_waitcnt lgkmcnt(0)
    v_readfirstlane_b32 s6, v15
    s_nop 0
    s_cmp_ge_u32 s6, 8
    s_cbranch_scc1 L_lwd_67
    s_add_u32 s52, s52, 1
    s_cmp_lt_u32 s52, 400000
    s_cbranch_scc1 L_lw_66
L_lwd_67:
    ds_write_b128 v96, v[112:115]
    ds_write_b128 v97, v[116:119]
    ds_write_b128 v98, v[120:123]
    ds_write_b128 v99, v[124:127]
    s_waitcnt lgkmcnt(0)
    v_mov_b32 v15, 1
    s_mov_b64 exec, 1
    ds_add_u32 v1, v15 offset:12
    s_mov_b64 exec, -1
L_lw_68:
    ds_read_b32 v15, v1 offset:12
    s_waitcnt lgkmcnt(0)
    v_readfirstlane_b32 s6, v15
    s_nop 0
    s_cmp_ge_u32 s6, 12
    s_cbranch_scc1 L_lwd_69
    s_add_u32 s52, s52, 1
    s_cmp_lt_u32 s52, 400000
    s_cbranch_scc1 L_lw_68
L_lwd_69:
    ds_read_b128 v[64:67], v4
    ds_read_b128 v[68:71], v5
    ds_read_b128 v[72:75], v6
    ds_read_b128 v[76:79], v7
    ds_read_b128 v[80:83], v8
    ds_read_b128 v[84:87], v9
    ds_read_b128 v[88:91], v10
    ds_read_b128 v[92:95], v11 offset:0
    s_waitcnt lgkmcnt(7)
    v_mfma_f32_32x32x16_bf16 v[16:31], v[192:195], v[64:67], v[16:31]
    ds_read_b128 v[64:67], v4 offset:256
    s_waitcnt lgkmcnt(7)
    v_mfma_f32_32x32x16_bf16 v[16:31], v[196:199], v[68:71], v[16:31]
    ds_read_b128 v[68:71], v5 offset:256
    s_waitcnt lgkmcnt(7)
    v_mfma_f32_32x32x16_bf16 v[16:31], v[200:203], v[72:75], v[16:31]
    ds_read_b128 v[72:75], v6 offset:256
    s_waitcnt lgkmcnt(7)
    v_mfma_f32_32x32x16_bf16 v[16:31], v[204:207], v[76:79], v[16:31]
    ds_read_b128 v[76:79], v7 offset:256
    s_waitcnt lgkmcnt(7)
    v_mfma_f32_32x32x16_bf16 v[16:31], v[208:211], v[80:83], v[16:31]
    ds_read_b128 v[80:83], v8 offset:256
    s_waitcnt lgkmcnt(7)
    v_mfma_f32_32x32x16_bf16 v[16:31], v[212:215], v[84:87], v[16:31]
    ds_read_b128 v[84:87], v9 offset:256
    s_waitcnt lgkmcnt(7)
    v_mfma_f32_32x32x16_bf16 v[16:31], v[216:219], v[88:91], v[16:31]
    ds_read_b128 v[88:91], v10 offset:256
    s_waitcnt lgkmcnt(7)
    v_mfma_f32_32x32x16_bf16 v[16:31], v[220:223], v[92:95], v[16:31]
    ds_read_b128 v[92:95], v11 offset:256
    s_waitcnt lgkmcnt(7)
    v_mfma_f32_32x32x16_bf16 v[16:31], v[224:227], v[64:67], v[16:31]
    s_waitcnt lgkmcnt(6)
    v_mfma_f32_32x32x16_bf16 v[16:31], v[228:231], v[68:71], v[16:31]
    s_waitcnt lgkmcnt(5)
    v_mfma_f32_32x32x16_bf16 v[16:31], v[232:235], v[72:75], v[16:31]
    s_waitcnt lgkmcnt(4)
    v_mfma_f32_32x32x16_bf16 v[16:31], v[236:239], v[76:79], v[16:31]
    s_waitcnt lgkmcnt(3)
    v_mfma_f32_32x32x16_bf16 v[16:31], v[240:243], v[80:83], v[16:31]
    s_waitcnt lgkmcnt(2)
    v_mfma_f32_32x32x16_bf16 v[16:31], v[244:247], v[84:87], v[16:31]
    s_waitcnt lgkmcnt(1)
    v_mfma_f32_32x32x16_bf16 v[16:31], v[248:251], v[88:91], v[16:31]
    s_waitcnt lgkmcnt(0)
    v_mfma_f32_32x32x16_bf16 v[16:31], v[252:255], v[92:95], v[16:31]
    v_bfe_u32 v4, v0, 2, 2
    v_lshrrev_b32 v5, 5, v0
    v_lshl_add_u32 v6, v5, 2, v4
    v_lshlrev_b32 v6, 10, v6
    s_lshl_b32 s6, s3, 8
    v_add_u32 v6, s6, v6
    v_and_b32 v7, 1, v0
    v_lshl_add_u32 v6, v7, 3, v6
    v_lshl_or_b32 v4, v4, 2, v5
    v_and_b32 v7, 1, v2
    v_bfe_u32 v8, v0, 1, 1
    v_lshl_or_b32 v7, v7, 1, v8
    v_xor_b32 v4, v4, v7
    v_xor_b32 v7, 0, v4
    v_lshl_add_u32 v96, v7, 4, v6
    v_add_u32 v104, 0x10000, v96
    v_xor_b32 v7, 2, v4
    v_lshl_add_u32 v97, v7, 4, v6
    v_add_u32 v97, 0x2000, v97
    v_add_u32 v105, 0x10000, v97
    v_xor_b32 v7, 4, v4
    v_lshl_add_u32 v98, v7, 4, v6
    v_add_u32 v106, 0x10000, v98
    v_xor_b32 v7, 6, v4
    v_lshl_add_u32 v99, v7, 4, v6
    v_add_u32 v99, 0x2000, v99
    v_add_u32 v107, 0x10000, v99
    v_xor_b32 v7, 8, v4
    v_lshl_add_u32 v100, v7, 4, v6
    v_add_u32 v108, 0x10000, v100
    v_xor_b32 v7, 10, v4
    v_lshl_add_u32 v101, v7, 4, v6
    v_add_u32 v101, 0x2000, v101
    v_add_u32 v109, 0x10000, v101
    v_xor_b32 v7, 12, v4
    v_lshl_add_u32 v102, v7, 4, v6
    v_add_u32 v110, 0x10000, v102
    v_xor_b32 v7, 14, v4
    v_lshl_add_u32 v103, v7, 4, v6
    v_add_u32 v103, 0x2000, v103
    v_add_u32 v111, 0x10000, v103
    s_mov_b32 s60, 0x3e0293ee
    v_and_b32 v7, 31, v0
    v_lshl_add_u32 v7, v7, 2, v1
    s_lshl_b32 s6, s3, 7
    v_add_u32 v8, s6, v7
    v_max3_f32 v9, v16, v17, v18
    v_max3_f32 v9, v19, v20, v9
    v_max3_f32 v9, v21, v22, v9
    v_max3_f32 v9, v23, v24, v9
    v_max3_f32 v9, v25, v26, v9
    v_max3_f32 v9, v27, v28, v9
    v_max3_f32 v9, v29, v30, v9
    v_max_f32 v9, v31, v9
    v_mov_b32 v10, v9
    s_nop 1
    v_permlane32_swap_b32 v9, v10
    v_max_f32 v9, v9, v10
    ds_write_b32 v8, v9 offset:1024
    s_waitcnt lgkmcnt(0)
    v_mov_b32 v15, 1
    s_mov_b64 exec, 1
    ds_add_u32 v1, v15 offset:12
    s_mov_b64 exec, -1
L_lw_70:
    ds_read_b32 v15, v1 offset:12
    s_waitcnt lgkmcnt(0)
    v_readfirstlane_b32 s6, v15
    s_nop 0
    s_cmp_ge_u32 s6, 16
    s_cbranch_scc1 L_lwd_71
    s_add_u32 s52, s52, 1
    s_cmp_lt_u32 s52, 400000
    s_cbranch_scc1 L_lw_70
L_lwd_71:
    ds_read_b32 v64, v7 offset:1024
    ds_read_b32 v65, v7 offset:1152
    ds_read_b32 v66, v7 offset:1280
    ds_read_b32 v67, v7 offset:1408
    s_waitcnt lgkmcnt(0)
    v_max3_f32 v9, v64, v65, v66
    v_max_f32 v9, v67, v9
    v_mul_f32 v10, s60, v9
    v_fma_f32 v16, v16, s60, -v10
    v_fma_f32 v17, v17, s60, -v10
    v_fma_f32 v18, v18, s60, -v10
    v_fma_f32 v19, v19, s60, -v10
    v_fma_f32 v20, v20, s60, -v10
    v_fma_f32 v21, v21, s60, -v10
    v_fma_f32 v22, v22, s60, -v10
    v_fma_f32 v23, v23, s60, -v10
    v_fma_f32 v24, v24, s60, -v10
    v_fma_f32 v25, v25, s60, -v10
    v_fma_f32 v26, v26, s60, -v10
    v_fma_f32 v27, v27, s60, -v10
    v_fma_f32 v28, v28, s60, -v10
    v_fma_f32 v29, v29, s60, -v10
    v_fma_f32 v30, v30, s60, -v10
    v_fma_f32 v31, v31, s60, -v10
    v_exp_f32 v16, v16
    v_exp_f32 v17, v17
    v_exp_f32 v18, v18
    v_exp_f32 v19, v19
    v_exp_f32 v20, v20
    v_exp_f32 v21, v21
    v_exp_f32 v22, v22
    v_exp_f32 v23, v23
    v_exp_f32 v24, v24
    v_exp_f32 v25, v25
    v_exp_f32 v26, v26
    v_exp_f32 v27, v27
    v_exp_f32 v28, v28
    v_exp_f32 v29, v29
    v_exp_f32 v30, v30
    v_exp_f32 v31, v31
    v_cvt_pk_bf16_f32 v64, v16, v17
    v_cvt_pk_bf16_f32 v65, v18, v19
    v_cvt_pk_bf16_f32 v66, v20, v21
    v_cvt_pk_bf16_f32 v67, v22, v23
    v_cvt_pk_bf16_f32 v68, v24, v25
    v_cvt_pk_bf16_f32 v69, v26, v27
    v_cvt_pk_bf16_f32 v70, v28, v29
    v_cvt_pk_bf16_f32 v71, v30, v31
    s_lshl_b32 s6, s3, 11
    s_add_u32 s6, s6, 0x20000
    v_add_u32 v11, s6, v13
    ds_write_b128 v11, v[64:67]
    ds_write_b128 v11, v[68:71] offset:1024
    v_add_f32 v16, v16, v24
    v_add_f32 v17, v17, v25
    v_add_f32 v18, v18, v26
    v_add_f32 v19, v19, v27
    v_add_f32 v20, v20, v28
    v_add_f32 v21, v21, v29
    v_add_f32 v22, v22, v30
    v_add_f32 v23, v23, v31
    v_add_f32 v16, v16, v20
    v_add_f32 v17, v17, v21
    v_add_f32 v18, v18, v22
    v_add_f32 v19, v19, v23
    v_add_f32 v16, v16, v18
    v_add_f32 v17, v17, v19
    v_add_f32 v16, v16, v17
    v_mov_b32 v9, v16
    s_nop 1
    v_permlane32_swap_b32 v16, v9
    v_add_f32 v9, v16, v9
    ds_write_b32 v8, v9 offset:1536
    s_waitcnt lgkmcnt(0)
    v_mov_b32 v15, 1
    s_mov_b64 exec, 1
    ds_add_u32 v1, v15 offset:12
    s_mov_b64 exec, -1
L_lw_72:
    ds_read_b32 v15, v1 offset:12
    s_waitcnt lgkmcnt(0)
    v_readfirstlane_b32 s6, v15
    s_nop 0
    s_cmp_ge_u32 s6, 20
    s_cbranch_scc1 L_lwd_73
    s_add_u32 s52, s52, 1
    s_cmp_lt_u32 s52, 400000
    s_cbranch_scc1 L_lw_72
L_lwd_73:
    v_add_u32 v11, 0x20000, v13
    ds_read_b128 v[192:195], v11 offset:0
    ds_read_b128 v[196:199], v11 offset:1024
    ds_read_b128 v[200:203], v11 offset:2048
    ds_read_b128 v[204:207], v11 offset:3072
    ds_read_b128 v[208:211], v11 offset:4096
    ds_read_b128 v[212:215], v11 offset:5120
    ds_read_b128 v[216:219], v11 offset:6144
    ds_read_b128 v[220:223], v11 offset:7168
    s_waitcnt lgkmcnt(0)
    ds_read_b64_tr_b16 v[224:225], v96 offset:0
    ds_read_b64_tr_b16 v[226:227], v97 offset:0
    ds_read_b64_tr_b16 v[228:229], v98 offset:0
    ds_read_b64_tr_b16 v[230:231], v99 offset:0
    ds_read_b64_tr_b16 v[232:233], v100 offset:0
    ds_read_b64_tr_b16 v[234:235], v101 offset:0
    ds_read_b64_tr_b16 v[236:237], v102 offset:0
    ds_read_b64_tr_b16 v[238:239], v103 offset:0
    ds_read_b64_tr_b16 v[240:241], v96 offset:16384
    ds_read_b64_tr_b16 v[242:243], v97 offset:16384
    ds_read_b64_tr_b16 v[244:245], v98 offset:16384
    ds_read_b64_tr_b16 v[246:247], v99 offset:16384
    ds_read_b64_tr_b16 v[248:249], v100 offset:16384
    ds_read_b64_tr_b16 v[250:251], v101 offset:16384
    s_waitcnt lgkmcnt(12)
    v_mfma_f32_32x32x16_bf16 v[128:143], v[192:195], v[224:227], 0
    ds_read_b64_tr_b16 v[252:253], v102 offset:16384
    ds_read_b64_tr_b16 v[254:255], v103 offset:16384
    s_waitcnt lgkmcnt(12)
    v_mfma_f32_32x32x16_bf16 v[144:159], v[192:195], v[228:231], 0
    ds_read_b64_tr_b16 v[224:225], v96 offset:32768
    ds_read_b64_tr_b16 v[226:227], v97 offset:32768
    s_waitcnt lgkmcnt(12)
    v_mfma_f32_32x32x16_bf16 v[160:175], v[192:195], v[232:235], 0
    ds_read_b64_tr_b16 v[228:229], v98 offset:32768
    ds_read_b64_tr_b16 v[230:231], v99 offset:32768
    s_waitcnt lgkmcnt(12)
    v_mfma_f32_32x32x16_bf16 v[176:191], v[192:195], v[236:239], 0
    ds_read_b64_tr_b16 v[232:233], v100 offset:32768
    ds_read_b64_tr_b16 v[234:235], v101 offset:32768
    s_waitcnt lgkmcnt(12)
    v_mfma_f32_32x32x16_bf16 v[128:143], v[196:199], v[240:243], v[128:143]
    ds_read_b64_tr_b16 v[236:237], v102 offset:32768
    ds_read_b64_tr_b16 v[238:239], v103 offset:32768
    s_waitcnt lgkmcnt(12)
    v_mfma_f32_32x32x16_bf16 v[144:159], v[196:199], v[244:247], v[144:159]
    ds_read_b64_tr_b16 v[240:241], v96 offset:49152
    ds_read_b64_tr_b16 v[242:243], v97 offset:49152
    s_waitcnt lgkmcnt(12)
    v_mfma_f32_32x32x16_bf16 v[160:175], v[196:199], v[248:251], v[160:175]
    ds_read_b64_tr_b16 v[244:245], v98 offset:49152
    ds_read_b64_tr_b16 v[246:247], v99 offset:49152
    s_waitcnt lgkmcnt(12)
    v_mfma_f32_32x32x16_bf16 v[176:191], v[196:199], v[252:255], v[176:191]
    ds_read_b64_tr_b16 v[248:249], v100 offset:49152
    ds_read_b64_tr_b16 v[250:251], v101 offset:49152
    s_waitcnt lgkmcnt(12)
    v_mfma_f32_32x32x16_bf16 v[128:143], v[200:203], v[224:227], v[128:143]
    ds_read_b64_tr_b16 v[252:253], v102 offset:49152
    ds_read_b64_tr_b16 v[254:255], v103 offset:49152
    s_waitcnt lgkmcnt(12)
    v_mfma_f32_32x32x16_bf16 v[144:159], v[200:203], v[228:231], v[144:159]
    ds_read_b64_tr_b16 v[224:225], v104 offset:0
    ds_read_b64_tr_b16 v[226:227], v105 offset:0
    s_waitcnt lgkmcnt(12)
    v_mfma_f32_32x32x16_bf16 v[160:175], v[200:203], v[232:235], v[160:175]
    ds_read_b64_tr_b16 v[228:229], v106 offset:0
    ds_read_b64_tr_b16 v[230:231], v107 offset:0
    s_waitcnt lgkmcnt(12)
    v_mfma_f32_32x32x16_bf16 v[176:191], v[200:203], v[236:239], v[176:191]
    ds_read_b64_tr_b16 v[232:233], v108 offset:0
    ds_read_b64_tr_b16 v[234:235], v109 offset:0
    s_waitcnt lgkmcnt(12)
    v_mfma_f32_32x32x16_bf16 v[128:143], v[204:207], v[240:243], v[128:143]
    ds_read_b64_tr_b16 v[236:237], v110 offset:0
    ds_read_b64_tr_b16 v[238:239], v111 offset:0
    s_waitcnt lgkmcnt(12)
    v_mfma_f32_32x32x16_bf16 v[144:159], v[204:207], v[244:247], v[144:159]
    ds_read_b64_tr_b16 v[240:241], v104 offset:16384
    ds_read_b64_tr_b16 v[242:243], v105 offset:16384
    s_waitcnt lgkmcnt(12)
    v_mfma_f32_32x32x16_bf16 v[160:175], v[204:207], v[248:251], v[160:175]
    ds_read_b64_tr_b16 v[244:245], v106 offset:16384
    ds_read_b64_tr_b16 v[246:247], v107 offset:16384
    s_waitcnt lgkmcnt(12)
    v_mfma_f32_32x32x16_bf16 v[176:191], v[204:207], v[252:255], v[176:191]
    ds_read_b64_tr_b16 v[248:249], v108 offset:16384
    ds_read_b64_tr_b16 v[250:251], v109 offset:16384
    s_waitcnt lgkmcnt(12)
    v_mfma_f32_32x32x16_bf16 v[128:143], v[208:211], v[224:227], v[128:143]
    ds_read_b64_tr_b16 v[252:253], v110 offset:16384
    ds_read_b64_tr_b16 v[254:255], v111 offset:16384
    s_waitcnt lgkmcnt(12)
    v_mfma_f32_32x32x16_bf16 v[144:159], v[208:211], v[228:231], v[144:159]
    ds_read_b64_tr_b16 v[224:225], v104 offset:32768
    ds_read_b64_tr_b16 v[226:227], v105 offset:32768
    s_waitcnt lgkmcnt(12)
    v_mfma_f32_32x32x16_bf16 v[160:175], v[208:211], v[232:235], v[160:175]
    ds_read_b64_tr_b16 v[228:229], v106 offset:32768
    ds_read_b64_tr_b16 v[230:231], v107 offset:32768
    s_waitcnt lgkmcnt(12)
    v_mfma_f32_32x32x16_bf16 v[176:191], v[208:211], v[236:239], v[176:191]
    ds_read_b64_tr_b16 v[232:233], v108 offset:32768
    ds_read_b64_tr_b16 v[234:235], v109 offset:32768
    s_waitcnt lgkmcnt(12)
    v_mfma_f32_32x32x16_bf16 v[128:143], v[212:215], v[240:243], v[128:143]
    ds_read_b64_tr_b16 v[236:237], v110 offset:32768
    ds_read_b64_tr_b16 v[238:239], v111 offset:32768
    s_waitcnt lgkmcnt(12)
    v_mfma_f32_32x32x16_bf16 v[144:159], v[212:215], v[244:247], v[144:159]
    ds_read_b64_tr_b16 v[240:241], v104 offset:49152
    ds_read_b64_tr_b16 v[242:243], v105 offset:49152
    s_waitcnt lgkmcnt(12)
    v_mfma_f32_32x32x16_bf16 v[160:175], v[212:215], v[248:251], v[160:175]
    ds_read_b64_tr_b16 v[244:245], v106 offset:49152
    ds_read_b64_tr_b16 v[246:247], v107 offset:49152
    s_waitcnt lgkmcnt(12)
    v_mfma_f32_32x32x16_bf16 v[176:191], v[212:215], v[252:255], v[176:191]
    ds_read_b64_tr_b16 v[248:249], v108 offset:49152
    ds_read_b64_tr_b16 v[250:251], v109 offset:49152
    s_waitcnt lgkmcnt(12)
    v_mfma_f32_32x32x16_bf16 v[128:143], v[216:219], v[224:227], v[128:143]
    ds_read_b64_tr_b16 v[252:253], v110 offset:49152
    ds_read_b64_tr_b16 v[254:255], v111 offset:49152
    s_waitcnt lgkmcnt(12)
    v_mfma_f32_32x32x16_bf16 v[144:159], v[216:219], v[228:231], v[144:159]
    s_waitcnt lgkmcnt(10)
    v_mfma_f32_32x32x16_bf16 v[160:175], v[216:219], v[232:235], v[160:175]
    s_waitcnt lgkmcnt(8)
    v_mfma_f32_32x32x16_bf16 v[176:191], v[216:219], v[236:239], v[176:191]
    s_waitcnt lgkmcnt(6)
    v_mfma_f32_32x32x16_bf16 v[128:143], v[220:223], v[240:243], v[128:143]
    s_waitcnt lgkmcnt(4)
    v_mfma_f32_32x32x16_bf16 v[144:159], v[220:223], v[244:247], v[144:159]
    s_waitcnt lgkmcnt(2)
    v_mfma_f32_32x32x16_bf16 v[160:175], v[220:223], v[248:251], v[160:175]
    s_waitcnt lgkmcnt(0)
    v_mfma_f32_32x32x16_bf16 v[176:191], v[220:223], v[252:255], v[176:191]
    v_lshlrev_b32 v9, 12, v5
    v_and_b32 v11, 1, v2
    v_lshl_add_u32 v9, v11, 10, v9
    v_lshl_add_u32 v9, v3, 4, v9
    s_lshl_b32 s6, s3, 8
    s_lshl_b32 s7, s54, 15
    s_add_u32 s6, s6, s7
    s_add_u32 s6, s6, 0x100000
    v_add_u32 v9, s6, v9
    ds_read_b32 v16, v7 offset:1536
    ds_read_b32 v17, v7 offset:1664
    ds_read_b32 v18, v7 offset:1792
    ds_read_b32 v19, v7 offset:1920
    v_cvt_pk_bf16_f32 v96, v128, v144
    v_cvt_pk_bf16_f32 v97, v160, v176
    v_cvt_pk_bf16_f32 v98, v129, v145
    v_cvt_pk_bf16_f32 v99, v161, v177
    s_movk_i32 s56, 0x0
    v_permlane16_swap_b32 v96, v98
    v_permlane16_swap_b32 v97, v99
    buffer_store_dwordx4 v[96:99], v9, s[48:51], s56 offen offset:0 sc1
    v_cvt_pk_bf16_f32 v100, v130, v146
    v_cvt_pk_bf16_f32 v101, v162, v178
    v_cvt_pk_bf16_f32 v102, v131, v147
    v_cvt_pk_bf16_f32 v103, v163, v179
    s_movk_i32 s56, 0x0
    v_permlane16_swap_b32 v100, v102
    v_permlane16_swap_b32 v101, v103
    buffer_store_dwordx4 v[100:103], v9, s[48:51], s56 offen offset:2048 sc1
    v_cvt_pk_bf16_f32 v104, v132, v148
    v_cvt_pk_bf16_f32 v105, v164, v180
    v_cvt_pk_bf16_f32 v106, v133, v149
    v_cvt_pk_bf16_f32 v107, v165, v181
    s_movk_i32 s56, 0x2000
    v_permlane16_swap_b32 v104, v106
    v_permlane16_swap_b32 v105, v107
    buffer_store_dwordx4 v[104:107], v9, s[48:51], s56 offen offset:0 sc1
    v_cvt_pk_bf16_f32 v108, v134, v150
    v_cvt_pk_bf16_f32 v109, v166, v182
    v_cvt_pk_bf16_f32 v110, v135, v151
    v_cvt_pk_bf16_f32 v111, v167, v183
    s_movk_i32 s56, 0x2000
    v_permlane16_swap_b32 v108, v110
    v_permlane16_swap_b32 v109, v111
    buffer_store_dwordx4 v[108:111], v9, s[48:51], s56 offen offset:2048 sc1
    v_cvt_pk_bf16_f32 v112, v136, v152
    v_cvt_pk_bf16_f32 v113, v168, v184
    v_cvt_pk_bf16_f32 v114, v137, v153
    v_cvt_pk_bf16_f32 v115, v169, v185
    s_movk_i32 s56, 0x4000
    v_permlane16_swap_b32 v112, v114
    v_permlane16_swap_b32 v113, v115
    buffer_store_dwordx4 v[112:115], v9, s[48:51], s56 offen offset:0 sc1
    v_cvt_pk_bf16_f32 v116, v138, v154
    v_cvt_pk_bf16_f32 v117, v170, v186
    v_cvt_pk_bf16_f32 v118, v139, v155
    v_cvt_pk_bf16_f32 v119, v171, v187
    s_movk_i32 s56, 0x4000
    v_permlane16_swap_b32 v116, v118
    v_permlane16_swap_b32 v117, v119
    buffer_store_dwordx4 v[116:119], v9, s[48:51], s56 offen offset:2048 sc1
    v_cvt_pk_bf16_f32 v120, v140, v156
    v_cvt_pk_bf16_f32 v121, v172, v188
    v_cvt_pk_bf16_f32 v122, v141, v157
    v_cvt_pk_bf16_f32 v123, v173, v189
    s_movk_i32 s56, 0x6000
    v_permlane16_swap_b32 v120, v122
    v_permlane16_swap_b32 v121, v123
    buffer_store_dwordx4 v[120:123], v9, s[48:51], s56 offen offset:0 sc1
    v_cvt_pk_bf16_f32 v124, v142, v158
    v_cvt_pk_bf16_f32 v125, v174, v190
    v_cvt_pk_bf16_f32 v126, v143, v159
    v_cvt_pk_bf16_f32 v127, v175, v191
    s_movk_i32 s56, 0x6000
    v_permlane16_swap_b32 v124, v126
    v_permlane16_swap_b32 v125, v127
    buffer_store_dwordx4 v[124:127], v9, s[48:51], s56 offen offset:2048 sc1
    s_lshl_b32 s6, s54, 8
    s_add_u32 s6, s6, 0x390000
    s_cmp_eq_u32 s3, 0
    s_cselect_b32 s6, s6, 0x40000000
    v_lshlrev_b32 v9, 3, v0
    v_add_u32 v9, s6, v9
    s_waitcnt lgkmcnt(0)
    v_add_f32 v16, v16, v17
    v_add_f32 v18, v18, v19
    v_add_f32 v95, v16, v18
    v_mov_b32 v94, v10
    s_mov_b32 exec_hi, 0
    buffer_store_dwordx2 v[94:95], v9, s[48:51], 0 offen sc1
    s_mov_b64 exec, -1
    s_add_u32 s6, s61, 16
    s_and_b32 s6, s6, 511
    s_lshl_b32 s55, s6, 12
    buffer_load_dwordx4 v[128:131], v13, s[12:15], s55 offen offset:0 nt
    buffer_load_dwordx4 v[132:135], v13, s[12:15], s55 offen offset:1024 nt
    buffer_load_dwordx4 v[136:139], v13, s[12:15], s55 offen offset:2048 nt
    buffer_load_dwordx4 v[140:143], v13, s[12:15], s55 offen offset:3072 nt
    s_add_u32 s6, s61, 24
    s_and_b32 s6, s6, 511
    s_lshl_b32 s55, s6, 12
    buffer_load_dwordx4 v[144:147], v13, s[12:15], s55 offen offset:0 nt
    buffer_load_dwordx4 v[148:151], v13, s[12:15], s55 offen offset:1024 nt
    buffer_load_dwordx4 v[152:155], v13, s[12:15], s55 offen offset:2048 nt
    buffer_load_dwordx4 v[156:159], v13, s[12:15], s55 offen offset:3072 nt
    s_lshl_b32 s6, s3, 11
    v_lshl_add_u32 v92, v0, 2, v1
    v_add_u32 v92, s6, v92
    ds_read_b32 v108, v92 offset:5120
    ds_read_b32 v109, v92 offset:5376
    ds_read_b32 v110, v92 offset:5632
    ds_read_b32 v111, v92 offset:5888
    ds_read_b32 v112, v92 offset:6144
    v_and_b32 v10, 1, v3
    v_lshlrev_b32 v10, 4, v10
    v_mov_b32 v11, 0xffff
    v_lshlrev_b32 v10, v10, v11
    v_bfe_u32 v11, v3, 1, 2
    v_cmp_eq_u32 vcc, 0, v11
    s_nop 1
    v_cndmask_b32 v4, 0, v10, vcc
    v_cmp_eq_u32 vcc, 1, v11
    s_nop 1
    v_cndmask_b32 v5, 0, v10, vcc
    v_cmp_eq_u32 vcc, 2, v11
    s_nop 1
    v_cndmask_b32 v6, 0, v10, vcc
    v_cmp_eq_u32 vcc, 3, v11
    s_nop 1
    v_cndmask_b32 v7, 0, v10, vcc
    s_lshr_b32 s59, s4, 3
    s_mul_i32 s59, s59, 128
    s_lshl_b32 s6, s3, 9
    v_and_b32 v14, 7, v0
    v_lshl_add_u32 v14, v2, 3, v14
    v_lshl_add_u32 v14, v14, 4, v1
    v_add_u32 v14, s6, v14
    s_lshl_b32 s6, s3, 3
    v_add_u32 v15, s6, v1
    s_mov_b32 s72, s36
    s_mov_b32 s73, s37
    s_mov_b32 s74, 0x400000
    s_mov_b32 s75, 0x20000
    s_mov_b32 s76, s26
    s_mov_b32 s77, s27
    s_mov_b32 s78, 0x400000
    s_mov_b32 s79, 0x20000
    s_bfe_u32 s6, s2, 0x20003
    s_lshl2_add_u32 s6, s5, s6
    s_lshr_b32 s7, s2, 5
    s_lshl_b32 s6, s6, 17
    s_lshl_b32 s7, s7, 7
    s_add_u32 s63, s6, s7
    s_lshl_b32 s6, s4, 17
    s_lshl_b32 s7, s5, 7
    s_add_u32 s80, s6, s7
    v_lshrrev_b32 v104, 3, v0
    v_lshlrev_b32 v104, 10, v104
    v_and_b32 v10, 7, v0
    v_lshl_add_u32 v104, v10, 4, v104
    v_lshl_add_u32 v96, v0, 3, v1
    s_mul_i32 s6, s5, 0x300
    s_add_u32 s6, s6, 0x2980
    v_lshlrev_b32 v97, 2, v0
    v_add_u32 v97, s6, v97
    v_mov_b32 v98, 0x40000000
    v_writelane_b32 v98, s6, 0
    v_xor_b32 v105, 32, v104
    v_xor_b32 v106, 64, v104
    v_xor_b32 v107, 96, v104
    v_mov_b32 v88, 0xff7fffff
    v_mov_b32 v89, 0
    v_mov_b32 v68, 0
    v_mov_b32 v69, 0
    v_mov_b32 v70, 0
    v_mov_b32 v71, 0
    s_mov_b32 s60, 0x3e0293ee
    v_and_b32 v11, 3, v0
    v_lshl_add_u32 v11, v2, 2, v11
    v_lshl_add_u32 v11, v11, 4, v1
    ds_read_b128 v[84:87], v11 offset:256
    v_lshrrev_b32 v11, 2, v3
    s_waitcnt lgkmcnt(0)
    v_cmp_eq_u32 vcc, 0, v11
    s_nop 1
    v_cndmask_b32 v16, 0, v84, vcc
    v_cndmask_b32 v17, 0, v85, vcc
    v_cndmask_b32 v18, 0, v86, vcc
    v_cndmask_b32 v19, 0, v87, vcc
    v_cmp_eq_u32 vcc, 1, v11
    s_nop 1
    v_cndmask_b32 v20, 0, v84, vcc
    v_cndmask_b32 v21, 0, v85, vcc
    v_cndmask_b32 v22, 0, v86, vcc
    v_cndmask_b32 v23, 0, v87, vcc
    v_cmp_eq_u32 vcc, 2, v11
    s_nop 1
    v_cndmask_b32 v24, 0, v84, vcc
    v_cndmask_b32 v25, 0, v85, vcc
    v_cndmask_b32 v26, 0, v86, vcc
    v_cndmask_b32 v27, 0, v87, vcc
    v_cmp_eq_u32 vcc, 3, v11
    s_nop 1
    v_cndmask_b32 v28, 0, v84, vcc
    v_cndmask_b32 v29, 0, v85, vcc
    v_cndmask_b32 v30, 0, v86, vcc
    v_cndmask_b32 v31, 0, v87, vcc
    v_mul_f32 v108, s60, v108
    v_max_f32 v88, v108, v88
    v_mul_f32 v109, s60, v109
    v_max_f32 v88, v109, v88
    v_mul_f32 v110, s60, v110
    v_max_f32 v88, v110, v88
    v_mul_f32 v111, s60, v111
    v_max_f32 v88, v111, v88
    v_mul_f32 v112, s60, v112
    v_max_f32 v88, v112, v88
    s_nop 1
    v_max_f32_dpp v88, v88, v88 row_ror:4 row_mask:0xf bank_mask:0xf
    s_nop 1
    v_max_f32_dpp v88, v88, v88 row_ror:8 row_mask:0xf bank_mask:0xf
    v_mov_b32 v92, v88
    s_nop 1
    v_permlane16_swap_b32 v88, v92
    v_max_f32 v88, v88, v92
    v_mov_b32 v92, v88
    s_nop 1
    v_permlane32_swap_b32 v88, v92
    v_max_f32 v88, v88, v92
    v_sub_f32 v90, v108, v88
    v_exp_f32 v90, v90
    s_nop 0
    v_add_f32 v89, v89, v90
    v_cvt_pk_bf16_f32 v90, v90, v90
    s_nop 1
    v_and_b32_dpp v72, v90, v4 row_newbcast:0 row_mask:0xf bank_mask:0xf
    v_and_b32_dpp v73, v90, v5 row_newbcast:0 row_mask:0xf bank_mask:0xf
    v_and_b32_dpp v74, v90, v6 row_newbcast:0 row_mask:0xf bank_mask:0xf
    v_and_b32_dpp v75, v90, v7 row_newbcast:0 row_mask:0xf bank_mask:0xf
    v_and_b32_dpp v76, v90, v4 row_newbcast:4 row_mask:0xf bank_mask:0xf
    v_and_b32_dpp v77, v90, v5 row_newbcast:4 row_mask:0xf bank_mask:0xf
    v_and_b32_dpp v78, v90, v6 row_newbcast:4 row_mask:0xf bank_mask:0xf
    v_and_b32_dpp v79, v90, v7 row_newbcast:4 row_mask:0xf bank_mask:0xf
    v_and_b32_dpp v80, v90, v4 row_newbcast:8 row_mask:0xf bank_mask:0xf
    v_and_b32_dpp v81, v90, v5 row_newbcast:8 row_mask:0xf bank_mask:0xf
    v_and_b32_dpp v82, v90, v6 row_newbcast:8 row_mask:0xf bank_mask:0xf
    v_and_b32_dpp v83, v90, v7 row_newbcast:8 row_mask:0xf bank_mask:0xf
    v_and_b32_dpp v84, v90, v4 row_newbcast:12 row_mask:0xf bank_mask:0xf
    v_and_b32_dpp v85, v90, v5 row_newbcast:12 row_mask:0xf bank_mask:0xf
    v_and_b32_dpp v86, v90, v6 row_newbcast:12 row_mask:0xf bank_mask:0xf
    v_and_b32_dpp v87, v90, v7 row_newbcast:12 row_mask:0xf bank_mask:0xf
    v_mfma_f32_16x16x32_bf16 v[68:71], v[32:35], v[72:75], v[68:71]
    v_mfma_f32_16x16x32_bf16 v[68:71], v[36:39], v[76:79], v[68:71]
    v_mfma_f32_16x16x32_bf16 v[68:71], v[40:43], v[80:83], v[68:71]
    v_mfma_f32_16x16x32_bf16 v[68:71], v[44:47], v[84:87], v[68:71]
    v_sub_f32 v90, v109, v88
    v_exp_f32 v90, v90
    s_nop 0
    v_add_f32 v89, v89, v90
    v_cvt_pk_bf16_f32 v90, v90, v90
    s_nop 1
    v_and_b32_dpp v72, v90, v4 row_newbcast:0 row_mask:0xf bank_mask:0xf
    v_and_b32_dpp v73, v90, v5 row_newbcast:0 row_mask:0xf bank_mask:0xf
    v_and_b32_dpp v74, v90, v6 row_newbcast:0 row_mask:0xf bank_mask:0xf
    v_and_b32_dpp v75, v90, v7 row_newbcast:0 row_mask:0xf bank_mask:0xf
    v_and_b32_dpp v76, v90, v4 row_newbcast:4 row_mask:0xf bank_mask:0xf
    v_and_b32_dpp v77, v90, v5 row_newbcast:4 row_mask:0xf bank_mask:0xf
    v_and_b32_dpp v78, v90, v6 row_newbcast:4 row_mask:0xf bank_mask:0xf
    v_and_b32_dpp v79, v90, v7 row_newbcast:4 row_mask:0xf bank_mask:0xf
    v_and_b32_dpp v80, v90, v4 row_newbcast:8 row_mask:0xf bank_mask:0xf
    v_and_b32_dpp v81, v90, v5 row_newbcast:8 row_mask:0xf bank_mask:0xf
    v_and_b32_dpp v82, v90, v6 row_newbcast:8 row_mask:0xf bank_mask:0xf
    v_and_b32_dpp v83, v90, v7 row_newbcast:8 row_mask:0xf bank_mask:0xf
    v_and_b32_dpp v84, v90, v4 row_newbcast:12 row_mask:0xf bank_mask:0xf
    v_and_b32_dpp v85, v90, v5 row_newbcast:12 row_mask:0xf bank_mask:0xf
    v_and_b32_dpp v86, v90, v6 row_newbcast:12 row_mask:0xf bank_mask:0xf
    v_and_b32_dpp v87, v90, v7 row_newbcast:12 row_mask:0xf bank_mask:0xf
    v_mfma_f32_16x16x32_bf16 v[68:71], v[48:51], v[72:75], v[68:71]
    v_mfma_f32_16x16x32_bf16 v[68:71], v[52:55], v[76:79], v[68:71]
    v_mfma_f32_16x16x32_bf16 v[68:71], v[56:59], v[80:83], v[68:71]
    v_mfma_f32_16x16x32_bf16 v[68:71], v[60:63], v[84:87], v[68:71]
    v_sub_f32 v90, v110, v88
    v_exp_f32 v90, v90
    s_nop 0
    v_add_f32 v89, v89, v90
    v_cvt_pk_bf16_f32 v90, v90, v90
    s_nop 1
    v_and_b32_dpp v72, v90, v4 row_newbcast:0 row_mask:0xf bank_mask:0xf
    v_and_b32_dpp v73, v90, v5 row_newbcast:0 row_mask:0xf bank_mask:0xf
    v_and_b32_dpp v74, v90, v6 row_newbcast:0 row_mask:0xf bank_mask:0xf
    v_and_b32_dpp v75, v90, v7 row_newbcast:0 row_mask:0xf bank_mask:0xf
    v_and_b32_dpp v76, v90, v4 row_newbcast:4 row_mask:0xf bank_mask:0xf
    v_and_b32_dpp v77, v90, v5 row_newbcast:4 row_mask:0xf bank_mask:0xf
    v_and_b32_dpp v78, v90, v6 row_newbcast:4 row_mask:0xf bank_mask:0xf
    v_and_b32_dpp v79, v90, v7 row_newbcast:4 row_mask:0xf bank_mask:0xf
    v_and_b32_dpp v80, v90, v4 row_newbcast:8 row_mask:0xf bank_mask:0xf
    v_and_b32_dpp v81, v90, v5 row_newbcast:8 row_mask:0xf bank_mask:0xf
    v_and_b32_dpp v82, v90, v6 row_newbcast:8 row_mask:0xf bank_mask:0xf
    v_and_b32_dpp v83, v90, v7 row_newbcast:8 row_mask:0xf bank_mask:0xf
    v_and_b32_dpp v84, v90, v4 row_newbcast:12 row_mask:0xf bank_mask:0xf
    v_and_b32_dpp v85, v90, v5 row_newbcast:12 row_mask:0xf bank_mask:0xf
    v_and_b32_dpp v86, v90, v6 row_newbcast:12 row_mask:0xf bank_mask:0xf
    v_and_b32_dpp v87, v90, v7 row_newbcast:12 row_mask:0xf bank_mask:0xf
    s_waitcnt vmcnt(8)

L_ATT_fin:
    v_mov_b32 v93, 1
    s_mov_b64 exec, 1
    ds_add_rtn_u32 v93, v1, v93 offset:16
    s_mov_b64 exec, -1
    s_waitcnt lgkmcnt(0)
    v_readfirstlane_b32 s6, v93
    s_nop 0
    s_cmp_eq_u32 s6, 3
    s_cbranch_scc0 L_ATT_done
    s_mov_b32 s6, 1
    s_mov_b32 s7, 0x384080
    s_atomic_add s6, s[42:43], s7 glc
    v_lshlrev_b32 v93, 8, v0
    v_add_u32 v93, 0x384000, v93
    v_mov_b32 v94, 0
    s_waitcnt lgkmcnt(0)
    s_cmp_eq_u32 s6, 62
    s_cbranch_scc0 L_ATT_done
    s_mov_b32 exec_hi, 0
    buffer_store_dword v94, v93, s[48:51], 0 offen sc1
    s_mov_b64 exec, -1
L_ATT_done:
    s_waitcnt vmcnt(4)
    s_add_u32 s6, s61, 32
    s_and_b32 s6, s6, 511
    s_lshl_b32 s55, s6, 12
    buffer_load_dwordx4 v[160:163], v13, s[12:15], s55 offen offset:0 nt
    buffer_load_dwordx4 v[164:167], v13, s[12:15], s55 offen offset:1024 nt
    buffer_load_dwordx4 v[168:171], v13, s[12:15], s55 offen offset:2048 nt
    buffer_load_dwordx4 v[172:175], v13, s[12:15], s55 offen offset:3072 nt
    v_mfma_f32_16x16x32_bf16 v[68:71], v[128:131], v[72:75], v[68:71]
    v_mfma_f32_16x16x32_bf16 v[68:71], v[132:135], v[76:79], v[68:71]
    v_mfma_f32_16x16x32_bf16 v[68:71], v[136:139], v[80:83], v[68:71]
    v_mfma_f32_16x16x32_bf16 v[68:71], v[140:143], v[84:87], v[68:71]
    v_sub_f32 v90, v111, v88
    v_exp_f32 v90, v90
    s_nop 0
    v_add_f32 v89, v89, v90
    v_cvt_pk_bf16_f32 v90, v90, v90
    s_nop 1
    v_and_b32_dpp v72, v90, v4 row_newbcast:0 row_mask:0xf bank_mask:0xf
    v_and_b32_dpp v73, v90, v5 row_newbcast:0 row_mask:0xf bank_mask:0xf
    v_and_b32_dpp v74, v90, v6 row_newbcast:0 row_mask:0xf bank_mask:0xf
    v_and_b32_dpp v75, v90, v7 row_newbcast:0 row_mask:0xf bank_mask:0xf
    v_and_b32_dpp v76, v90, v4 row_newbcast:4 row_mask:0xf bank_mask:0xf
    v_and_b32_dpp v77, v90, v5 row_newbcast:4 row_mask:0xf bank_mask:0xf
    v_and_b32_dpp v78, v90, v6 row_newbcast:4 row_mask:0xf bank_mask:0xf
    v_and_b32_dpp v79, v90, v7 row_newbcast:4 row_mask:0xf bank_mask:0xf
    v_and_b32_dpp v80, v90, v4 row_newbcast:8 row_mask:0xf bank_mask:0xf
    v_and_b32_dpp v81, v90, v5 row_newbcast:8 row_mask:0xf bank_mask:0xf
    v_and_b32_dpp v82, v90, v6 row_newbcast:8 row_mask:0xf bank_mask:0xf
    v_and_b32_dpp v83, v90, v7 row_newbcast:8 row_mask:0xf bank_mask:0xf
    v_and_b32_dpp v84, v90, v4 row_newbcast:12 row_mask:0xf bank_mask:0xf
    v_and_b32_dpp v85, v90, v5 row_newbcast:12 row_mask:0xf bank_mask:0xf
    v_and_b32_dpp v86, v90, v6 row_newbcast:12 row_mask:0xf bank_mask:0xf
    v_and_b32_dpp v87, v90, v7 row_newbcast:12 row_mask:0xf bank_mask:0xf
    s_waitcnt vmcnt(4)
    s_add_u32 s6, s61, 40
    s_and_b32 s6, s6, 511
    s_lshl_b32 s55, s6, 12
    buffer_load_dwordx4 v[32:35], v12, s[8:11], s55 offen offset:0 nt
    buffer_load_dwordx4 v[36:39], v12, s[8:11], s55 offen offset:1024 nt
    buffer_load_dwordx4 v[40:43], v12, s[8:11], s55 offen offset:2048 nt
    buffer_load_dwordx4 v[44:47], v12, s[8:11], s55 offen offset:3072 nt
    v_mfma_f32_16x16x32_bf16 v[68:71], v[144:147], v[72:75], v[68:71]
    v_mfma_f32_16x16x32_bf16 v[68:71], v[148:151], v[76:79], v[68:71]
    v_mfma_f32_16x16x32_bf16 v[68:71], v[152:155], v[80:83], v[68:71]
    v_mfma_f32_16x16x32_bf16 v[68:71], v[156:159], v[84:87], v[68:71]
    v_sub_f32 v90, v112, v88
    v_exp_f32 v90, v90
    s_nop 0
    v_add_f32 v89, v89, v90
    v_cvt_pk_bf16_f32 v90, v90, v90
    s_nop 1
    v_and_b32_dpp v72, v90, v4 row_newbcast:0 row_mask:0xf bank_mask:0xf
    v_and_b32_dpp v73, v90, v5 row_newbcast:0 row_mask:0xf bank_mask:0xf
    v_and_b32_dpp v74, v90, v6 row_newbcast:0 row_mask:0xf bank_mask:0xf
    v_and_b32_dpp v75, v90, v7 row_newbcast:0 row_mask:0xf bank_mask:0xf
    v_and_b32_dpp v76, v90, v4 row_newbcast:4 row_mask:0xf bank_mask:0xf
    v_and_b32_dpp v77, v90, v5 row_newbcast:4 row_mask:0xf bank_mask:0xf
    v_and_b32_dpp v78, v90, v6 row_newbcast:4 row_mask:0xf bank_mask:0xf
    v_and_b32_dpp v79, v90, v7 row_newbcast:4 row_mask:0xf bank_mask:0xf
    v_and_b32_dpp v80, v90, v4 row_newbcast:8 row_mask:0xf bank_mask:0xf
    v_and_b32_dpp v81, v90, v5 row_newbcast:8 row_mask:0xf bank_mask:0xf
    v_and_b32_dpp v82, v90, v6 row_newbcast:8 row_mask:0xf bank_mask:0xf
    v_and_b32_dpp v83, v90, v7 row_newbcast:8 row_mask:0xf bank_mask:0xf
    v_and_b32_dpp v84, v90, v4 row_newbcast:12 row_mask:0xf bank_mask:0xf
    v_and_b32_dpp v85, v90, v5 row_newbcast:12 row_mask:0xf bank_mask:0xf
    v_and_b32_dpp v86, v90, v6 row_newbcast:12 row_mask:0xf bank_mask:0xf
    v_and_b32_dpp v87, v90, v7 row_newbcast:12 row_mask:0xf bank_mask:0xf
    s_waitcnt vmcnt(4)
    s_add_u32 s6, s61, 40
    s_and_b32 s6, s6, 511
    s_lshl_b32 s55, s6, 12
    buffer_load_dwordx4 v[48:51], v13, s[12:15], s55 offen offset:0 nt
    buffer_load_dwordx4 v[52:55], v13, s[12:15], s55 offen offset:1024 nt
    buffer_load_dwordx4 v[56:59], v13, s[12:15], s55 offen offset:2048 nt
    buffer_load_dwordx4 v[60:63], v13, s[12:15], s55 offen offset:3072 nt
    v_mfma_f32_16x16x32_bf16 v[68:71], v[160:163], v[72:75], v[68:71]
    v_mfma_f32_16x16x32_bf16 v[68:71], v[164:167], v[76:79], v[68:71]
    v_mfma_f32_16x16x32_bf16 v[68:71], v[168:171], v[80:83], v[68:71]
    v_mfma_f32_16x16x32_bf16 v[68:71], v[172:175], v[84:87], v[68:71]
    s_add_u32 s83, s83, 40
    s_mov_b32 s57, s83
    s_add_u32 s6, s57, s84
    s_sub_u32 s62, s6, 385
    s_cmp_lt_u32 s6, s85
    s_cbranch_scc1 L_nt_74
    s_mov_b32 s62, 1
    s_atomic_add s62, s[68:69], 0x0 glc
L_nt_74:
    s_branch L_BLOOP
L_END:
    s_endpgm
.section .rodata,"a"
.p2align 6
.amdhsa_kernel concat_heads__compressed_kv_cla__mha_block_cached__decode_kernel
  .amdhsa_next_free_vgpr 256
  .amdhsa_next_free_sgpr 102
  .amdhsa_accum_offset 256
  .amdhsa_group_segment_fixed_size 0
  .amdhsa_kernarg_size 112
  .amdhsa_user_sgpr_count 2
  .amdhsa_user_sgpr_kernarg_segment_ptr 1
  .amdhsa_system_sgpr_workgroup_id_x 1
  .amdhsa_float_denorm_mode_32 3
.end_amdhsa_kernel
```
